```python
import torch

def _softmax(x, axis=-1):
    return torch.softmax(x, dim=axis)
def _gelu(x):
    return torch.nn.functional.gelu(x, approximate="tanh")
def _silu(x):
    return torch.nn.functional.silu(x)
def _sigmoid(x):
    return torch.sigmoid(x)
def _layernorm(x, axis=-1, eps=1e-5):
    m = x.mean(dim=axis, keepdim=True)
    v = x.var(dim=axis, keepdim=True, unbiased=False)
    return (x - m) / torch.sqrt(v + eps)
def _scatter_add(tgt, idx, src, axis=0):
    return tgt.clone().index_add_(axis, idx, src)
def _segment_sum(src, seg, n):
    out = torch.zeros((n,) + src.shape[1:], dtype=src.dtype)
    return out.index_add_(0, seg, src)
def _pad(x, pw):
    flat = tuple(v for pair in reversed(pw) for v in pair)
    return torch.nn.functional.pad(x, flat)

kernel_name = 'gather_scatter__edge_featured_mpnn_mpnn__graph'

def setup_inputs():

    _w = (lambda a: (lambda t: t.to(torch.bfloat16) if t.is_floating_point() else t)(torch.as_tensor(a)))
    N, deg, D, De = 10000, 64, 64, max(16, 1)
    E = N * deg
    H = 2 * D
    return {
        "x": _w((lambda *s: torch.randn(*s, dtype=torch.bfloat16) * 0.05)(N, D)),
        "e_attr": _w((lambda *s: torch.randn(*s, dtype=torch.bfloat16) * 0.8)(E, De)),
        "src": _w((lambda lo, hi, *s: torch.randint(lo, hi, s))(0, N, E).to(torch.int64)),
        "dst": _w((lambda lo, hi, *s: torch.randint(lo, hi, s))(0, N, E).to(torch.int64)),
        "w1": _w((lambda *s: torch.randn(*s, dtype=torch.bfloat16) * 0.8)(2 * D + De, H) * (1.0 / (2 * D + De) ** 0.5)),
        "b1": _w((lambda *s: torch.randn(*s, dtype=torch.bfloat16) * 0.4)(H) * 0.01),
        "w2": _w((lambda *s: torch.randn(*s, dtype=torch.bfloat16) * 0.05)(H, D) * (1.0 / H ** 0.5)),
        "b2": _w((lambda *s: torch.randn(*s, dtype=torch.bfloat16) * 0.05)(D) * 0.01),
    }

def reference(x, e_attr, src, dst, w1, b1, w2, b2):
    N, D = x.shape
    h_src = x[src]
    h_dst = x[dst]
    m_in = torch.concatenate([h_src, h_dst, e_attr], axis=-1)
    h = _silu(m_in @ w1 + b1)
    msg = h @ w2 + b2
    return _segment_sum(msg, dst, N)
```

```asm
; @launch grid=(256,1,1) block=(512,1,1) lds=161024
.amdgcn_target "amdgcn-amd-amdhsa--gfx950"
.text
.globl gather_scatter__edge_featured_mpnn_mpnn__graph_kernel
.p2align 8
.type gather_scatter__edge_featured_mpnn_mpnn__graph_kernel,@function
gather_scatter__edge_featured_mpnn_mpnn__graph_kernel:
    s_cmp_ge_u32 s2, 256
    s_cbranch_scc1 B_END
    s_load_dwordx16 s[48:63], s[0:1], 0
    s_load_dwordx4 s[96:99], s[0:1], 64
    s_load_dwordx2 s[100:101], s[0:1], 80
    s_memrealtime s[26:27]
    v_lshrrev_b32 v1, 6, v0
    v_and_b32 v211, 63, v0
    v_readfirstlane_b32 s32, v1
    s_mul_i32 s33, s2, 625
    s_add_u32 s28, s33, 640
    s_add_u32 s33, s33, 15
    s_lshr_b32 s33, s33, 4
    s_lshr_b32 s28, s28, 4
    s_sub_u32 s34, s28, s33
    s_and_b32 s35, s33, 63
    s_mul_i32 s36, s32, 6144
    s_add_u32 s36, s36, 65792
    s_mov_b32 s39, 0
    s_mov_b32 s40, 32
    s_mov_b32 s41, 0
    s_mov_b32 s46, 0x400000
    v_mov_b32 v210, 0
    v_mov_b32 v28, 0
    v_mov_b32 v29, 0
    v_mov_b32 v40, 0
    v_mov_b32 v41, 0
    v_mov_b32 v42, 0
    v_mov_b32 v43, 0
    v_lshlrev_b32 v2, 4, v0
    v_cmp_gt_u32 vcc, 64, v0
    s_nop 0
    s_and_saveexec_b64 s[24:25], vcc
    ds_write_b128 v2, v[40:43] offset:0
    s_mov_b64 exec, s[24:25]
    v_cmp_gt_u32 vcc, 0x88, v0
    s_nop 0
    s_and_saveexec_b64 s[24:25], vcc
    v_lshrrev_b32 v3, 3, v0
    v_and_b32 v4, 7, v0
    v_lshrrev_b32 v5, 1, v3
    v_and_b32 v6, 1, v3
    v_lshlrev_b32 v6, 4, v6
    v_mov_b32 v7, 0x3f80
    v_lshlrev_b32 v7, v6, v7
    v_cmp_eq_u32 vcc, v4, v5
    v_lshlrev_b32 v8, 2, v0
    s_nop 0
    v_cndmask_b32 v7, 0, v7, vcc
    v_add_u32 v8, 65024, v8
    ds_write_b32 v8, v7
    s_mov_b64 exec, s[24:25]
    v_cmp_gt_u32 vcc, 16, v0
    s_nop 0
    s_and_saveexec_b64 s[24:25], vcc
    ds_write_b128 v2, v[40:43] offset:42496
    s_mov_b64 exec, s[24:25]
    s_waitcnt lgkmcnt(0)
    s_cmp_lg_u32 s2, 0
    s_cbranch_scc1 A_NONONCE
    s_cmp_lg_u32 s32, 0
    s_cbranch_scc1 A_NONONCE
    s_and_b32 s27, s27, 0xff
    s_or_b32 s27, s27, 0x80000000
    v_mov_b32 v4, s26
    v_mov_b32 v5, s27
    v_mov_b32 v3, 0
    s_mov_b64 exec, 1
    global_store_dwordx2 v3, v[4:5], s[98:99] sc1
    s_mov_b64 exec, -1
A_NONONCE:
    s_mov_b32 s16, s54
    s_and_b32 s17, s55, 0xffff
    s_mov_b32 s18, 2560000
    s_mov_b32 s19, 0x20000
    s_mov_b32 s20, s52
    s_and_b32 s21, s53, 0xffff
    s_mov_b32 s22, 2560000
    s_mov_b32 s23, 0x20000
    s_mul_i32 s28, s2, 10000
    v_add_u32 v3, 0x2000, v2
    v_mov_b32 v4, 0x7ffffff0
    v_cmp_gt_u32 vcc, 113, v0
    v_lshlrev_b32 v18, 2, v0
    v_add_u32 v18, 0x2000, v18
    v_cndmask_b32 v3, v4, v3, vcc
    v_cmp_gt_u32 vcc, 452, v0
    s_nop 0
    s_mov_b64 s[26:27], vcc
    v_cndmask_b32 v18, v4, v18, vcc
    buffer_load_dwordx4 v[40:43], v2, s[16:19], s28 offen
    buffer_load_dword v48, v18, s[16:19], s28 offen
    buffer_load_dwordx4 v[44:47], v2, s[20:23], s28 offen
    buffer_load_dword v52, v18, s[20:23], s28 offen
    s_barrier
    v_lshlrev_b32 v11, 16, v0
    v_lshlrev_b32 v12, 14, v0
    v_add_u32 v12, 0x2000000, v12
    s_mov_b32 s29, 429497
    s_waitcnt vmcnt(2)
    v_mov_b32 v13, 1
    v_mul_u32_u24 v56, s29, v40
    v_mul_u32_u24 v57, s29, v41
    v_mul_u32_u24 v58, s29, v42
    v_mul_u32_u24 v59, s29, v43
    v_lshrrev_b32 v56, 22, v56
    v_lshrrev_b32 v57, 22, v57
    v_lshrrev_b32 v58, 22, v58
    v_lshrrev_b32 v59, 22, v59
    v_and_b32 v56, 0x3fc, v56
    ds_add_rtn_u32 v64, v56, v13 offset:0
    v_and_b32 v57, 0x3fc, v57
    ds_add_rtn_u32 v65, v57, v13 offset:0
    v_and_b32 v58, 0x3fc, v58
    ds_add_rtn_u32 v66, v58, v13 offset:0
    v_and_b32 v59, 0x3fc, v59
    ds_add_rtn_u32 v67, v59, v13 offset:0
    s_mov_b64 exec, s[26:27]
    v_mul_u32_u24 v60, s29, v48
    v_lshrrev_b32 v60, 22, v60
    v_and_b32 v60, 0x3fc, v60
    ds_add_rtn_u32 v68, v60, v13 offset:0
    s_mov_b64 exec, -1
    s_waitcnt vmcnt(0)
    v_lshl_or_b32 v40, v40, 26, v44
    v_add_u32 v40, v40, v11
    v_lshl_or_b32 v41, v41, 26, v45
    v_add_u32 v41, v41, v11
    v_add_u32 v41, 0x4000, v41
    v_lshl_or_b32 v42, v42, 26, v46
    v_add_u32 v42, v42, v11
    v_add_u32 v42, 0x8000, v42
    v_lshl_or_b32 v43, v43, 26, v47
    v_add_u32 v43, v43, v11
    v_add_u32 v43, 0xc000, v43
    v_lshl_or_b32 v48, v48, 26, v52
    v_add_u32 v48, v48, v12
A_H1:
    s_waitcnt lgkmcnt(0)
    s_barrier
    v_lshlrev_b32 v14, 4, v211
    ds_read_b128 v[72:75], v14 offset:0
    v_mov_b32 v15, 0
    s_cmp_lg_u32 s32, 0
    s_cbranch_scc1 A_NOTAG0
    global_load_dwordx2 v[16:17], v15, s[98:99] sc1
A_NOTAG0:
    s_mov_b32 s16, s56
    s_and_b32 s17, s57, 0xffff
    s_mov_b32 s18, 36864
    s_mov_b32 s19, 0x20000
    s_mov_b32 s20, s48
    s_and_b32 s21, s49, 0xffff
    s_mov_b32 s22, 1280000
    s_mov_b32 s23, 0x20000
    v_lshlrev_b32 v1, 4, v211
    s_lshl_b32 s31, s32, 10
    s_add_u32 m0, s31, 65792
    s_add_u32 s30, s31, 0
    buffer_load_dwordx4 v1, s[16:19], s30 offen lds
    s_add_u32 m0, s31, 73984
    s_add_u32 s30, s31, 8192
    buffer_load_dwordx4 v1, s[16:19], s30 offen lds
    s_waitcnt lgkmcnt(0)
    v_add_u32 v76, v72, v73
    v_add_u32 v77, v76, v74
    v_add_u32 v78, v77, v75
    v_mov_b32 v79, v78
    s_add_u32 m0, s31, 82176
    s_add_u32 s30, s31, 16384
    buffer_load_dwordx4 v1, s[16:19], s30 offen lds
    v_add_u32_dpp v79, v79, v79 row_shr:1 row_mask:0xf bank_mask:0xf
    s_nop 1
    v_add_u32_dpp v79, v79, v79 row_shr:2 row_mask:0xf bank_mask:0xf
    s_nop 1
    v_add_u32_dpp v79, v79, v79 row_shr:4 row_mask:0xf bank_mask:0xf
    s_nop 1
    v_add_u32_dpp v79, v79, v79 row_shr:8 row_mask:0xf bank_mask:0xf
    s_nop 1
    v_add_u32_dpp v79, v79, v79 row_bcast:15 row_mask:0xa bank_mask:0xf
    s_nop 1
    v_add_u32_dpp v79, v79, v79 row_bcast:31 row_mask:0xc bank_mask:0xf
    v_sub_u32 v80, v79, v78
    v_add_u32 v81, v80, v72
    v_add_u32 v82, v80, v76
    v_add_u32 v83, v80, v77
    ds_write_b128 v14, v[80:83] offset:1024
    s_add_u32 m0, s31, 90368
    s_add_u32 s30, s31, 24576
    buffer_load_dwordx4 v1, s[16:19], s30 offen lds
    s_waitcnt lgkmcnt(0)
    ds_read_b32 v56, v56 offset:1024
    ds_read_b32 v57, v57 offset:1024
    ds_read_b32 v58, v58 offset:1024
    ds_read_b32 v59, v59 offset:1024
    ds_read_b32 v60, v60 offset:1024
    s_add_u32 m0, s31, 98560
    s_add_u32 s30, s31, 32768
    buffer_load_dwordx4 v1, s[16:19], s30 offen lds
    s_waitcnt lgkmcnt(4)
    v_add_lshl_u32 v56, v56, v64, 2
    ds_write_b32 v56, v40 offset:2048
    s_waitcnt lgkmcnt(3)
    v_add_lshl_u32 v57, v57, v65, 2
    ds_write_b32 v57, v41 offset:2048
    s_waitcnt lgkmcnt(2)
    v_add_lshl_u32 v58, v58, v66, 2
    ds_write_b32 v58, v42 offset:2048
    s_waitcnt lgkmcnt(1)
    v_add_lshl_u32 v59, v59, v67, 2
    ds_write_b32 v59, v43 offset:2048
    s_mov_b64 exec, s[26:27]
    s_waitcnt lgkmcnt(4)
    v_add_lshl_u32 v60, v60, v68, 2
    ds_write_b32 v60, v48 offset:2048
    s_mov_b64 exec, -1
    s_lshl_b32 s30, s32, 3
    v_lshrrev_b32 v5, 3, v211
    v_add_u32 v5, s30, v5
    v_bfe_u32 v6, v5, 1, 3
    v_and_b32 v7, 7, v211
    v_xor_b32 v6, v6, v7
    v_add_u32 v5, s33, v5
    v_lshlrev_b32 v5, 7, v5
    v_lshl_add_u32 v5, v6, 4, v5
    s_add_u32 m0, s31, 106752
    s_and_b32 s30, s32, 3
    buffer_load_dwordx4 v5, s[20:23], 0 offen lds
    s_lshl_b32 s30, s30, 5
    v_and_b32 v5, 31, v211
    v_lshrrev_b32 v222, 5, v211
    v_add_u32 v221, s30, v5
    v_lshlrev_b32 v9, 1, v221
    global_load_ushort v223, v9, s[58:59]
A_H2:
    s_mov_b32 s12, s100
    s_and_b32 s13, s101, 0xffff
    s_mov_b32 s14, 3088384
    s_mov_b32 s15, 0x20000
    s_waitcnt lgkmcnt(0)
    s_barrier
    ds_read_b128 v[40:43], v2 offset:2048
    ds_read_b128 v[44:47], v2 offset:10240
    s_mul_i32 s28, s2, 10000
    s_add_u32 s28, s28, 524288
    s_waitcnt lgkmcnt(1)
    buffer_store_dwordx4 v[40:43], v2, s[12:15], s28 offen sc1
    s_waitcnt lgkmcnt(0)
    buffer_store_dwordx4 v[44:47], v3, s[12:15], s28 offen sc1
    s_cmp_lg_u32 s32, 0
    s_cbranch_scc1 A_DRAIN
A_NONCE:
    s_waitcnt vmcnt(0)
    v_readfirstlane_b32 s43, v16
    v_readfirstlane_b32 s45, v17
    s_nop 0
    s_cmp_lt_i32 s45, 0
    s_cbranch_scc1 A_HAVETAG
A_NONCE2:
    s_sub_u32 s46, s46, 1
    s_cmp_eq_u32 s46, 0
    s_cbranch_scc1 B_END
    s_sleep 1
    global_load_dwordx2 v[16:17], v15, s[98:99] sc1
    s_waitcnt vmcnt(0)
    v_readfirstlane_b32 s43, v16
    v_readfirstlane_b32 s45, v17
    s_nop 0
    s_cmp_lt_i32 s45, 0
    s_cbranch_scc0 A_NONCE2
A_HAVETAG:
    v_and_b32 v17, 0xff, v17
    v_mov_b32 v15, 42496
    ds_write_b64 v15, v[16:17] offset:16
    s_and_b32 s45, s45, 0xff
A_DRAIN:
    s_waitcnt vmcnt(0) lgkmcnt(0)
    s_barrier
    s_cmp_lg_u32 s32, 0
    s_cbranch_scc1 A_PUBLISHED
    s_lshl_b32 s28, s45, 24
    v_mov_b32 v41, s43
    v_mov_b32 v43, s43
    v_mov_b32 v45, s43
    v_mov_b32 v47, s43
    v_lshl_or_b32 v40, v72, 12, v80
    v_lshl_or_b32 v42, v73, 12, v81
    v_lshl_or_b32 v44, v74, 12, v82
    v_lshl_or_b32 v46, v75, 12, v83
    v_or_b32 v40, s28, v40
    v_or_b32 v42, s28, v42
    v_or_b32 v44, s28, v44
    v_or_b32 v46, s28, v46
    v_lshlrev_b32 v14, 5, v211
    s_lshl_b32 s28, s2, 11
    s_add_u32 s28, s28, 0
    buffer_store_dwordx4 v[40:43], v14, s[12:15], s28 offen sc1
    buffer_store_dwordx4 v[44:47], v14, s[12:15], s28 offen offset:16 sc1
A_PUBLISHED:
    v_mov_b32 v15, 42496
    ds_read_b64 v[16:17], v15 offset:16
    v_lshrrev_b32 v4, 1, v0
    v_mul_u32_u24 v214, 2500, v4
    v_lshlrev_b32 v4, 11, v4
    s_waitcnt lgkmcnt(0)
    v_readfirstlane_b32 s43, v16
    v_readfirstlane_b32 s45, v17
    s_lshr_b32 s28, s32, 2
    s_lshl_b32 s28, s28, 12
    s_add_u32 s28, s28, 106752
    v_and_b32 v216, 31, v211
    v_bfe_u32 v217, v211, 1, 3
    v_lshlrev_b32 v216, 7, v216
    v_add_u32 v216, s28, v216
    v_or_b32 v218, 0, v222
    v_xor_b32 v218, v218, v217
    v_lshl_add_u32 v218, v218, 4, v216
    ds_read_b128 v[88:91], v218
    v_or_b32 v218, 2, v222
    v_xor_b32 v218, v218, v217
    v_lshl_add_u32 v218, v218, 4, v216
    ds_read_b128 v[92:95], v218
    v_or_b32 v218, 4, v222
    v_xor_b32 v218, v218, v217
    v_lshl_add_u32 v218, v218, 4, v216
    ds_read_b128 v[96:99], v218
    v_or_b32 v218, 6, v222
    v_xor_b32 v218, v218, v217
    v_lshl_add_u32 v218, v218, 4, v216
    ds_read_b128 v[100:103], v218
    v_lshrrev_b32 v27, 5, v211
    v_bfe_u32 v30, v211, 2, 2
    v_lshl_add_u32 v27, v27, 3, v30
    v_mul_u32_u24 v216, 256, v27
    v_bfe_u32 v27, v211, 4, 1
    v_lshl_add_u32 v216, v27, 5, v216
    v_and_b32 v27, 3, v211
    v_lshl_add_u32 v216, v27, 3, v216
    v_add_u32 v216, 65792, v216
    s_lshr_b32 s28, s32, 2
    s_lshl_b32 s28, s28, 12
    s_and_b32 s29, s32, 3
    s_lshl_b32 s29, s29, 6
    s_add_u32 s28, s28, s29
    v_add_u32 v217, s28, v216
    v_add_u32 v218, s29, v216
    ds_read_b64_tr_b16 v[112:113], v217 offset:0
    ds_read_b64_tr_b16 v[114:115], v217 offset:1024
    ds_read_b64_tr_b16 v[116:117], v217 offset:8192
    ds_read_b64_tr_b16 v[118:119], v217 offset:9216
    ds_read_b64_tr_b16 v[120:121], v218 offset:32768
    ds_read_b64_tr_b16 v[122:123], v218 offset:33792
    ds_read_b64_tr_b16 v[56:57], v218 offset:16384
    ds_read_b64_tr_b16 v[58:59], v218 offset:17408
    ds_read_b64_tr_b16 v[60:61], v218 offset:20480
    ds_read_b64_tr_b16 v[62:63], v218 offset:21504
    ds_read_b64_tr_b16 v[64:65], v218 offset:24576
    ds_read_b64_tr_b16 v[66:67], v218 offset:25600
    ds_read_b64_tr_b16 v[68:69], v218 offset:28672
    ds_read_b64_tr_b16 v[70:71], v218 offset:29696
    s_mov_b32 s30, 0xbfb8aa3b
    s_waitcnt lgkmcnt(8)
    v_lshlrev_b32 v219, 16, v112
    v_and_b32 v220, 0xffff0000, v112
    v_mul_f32 v219, s30, v219
    v_mul_f32 v220, s30, v220
    v_cvt_pk_bf16_f32 v112, v219, v220
    v_lshlrev_b32 v219, 16, v113
    v_and_b32 v220, 0xffff0000, v113
    v_mul_f32 v219, s30, v219
    v_mul_f32 v220, s30, v220
    v_cvt_pk_bf16_f32 v113, v219, v220
    v_lshlrev_b32 v219, 16, v114
    v_and_b32 v220, 0xffff0000, v114
    v_mul_f32 v219, s30, v219
    v_mul_f32 v220, s30, v220
    v_cvt_pk_bf16_f32 v114, v219, v220
    v_lshlrev_b32 v219, 16, v115
    v_and_b32 v220, 0xffff0000, v115
    v_mul_f32 v219, s30, v219
    v_mul_f32 v220, s30, v220
    v_cvt_pk_bf16_f32 v115, v219, v220
    v_lshlrev_b32 v219, 16, v116
    v_and_b32 v220, 0xffff0000, v116
    v_mul_f32 v219, s30, v219
    v_mul_f32 v220, s30, v220
    v_cvt_pk_bf16_f32 v116, v219, v220
    v_lshlrev_b32 v219, 16, v117
    v_and_b32 v220, 0xffff0000, v117
    v_mul_f32 v219, s30, v219
    v_mul_f32 v220, s30, v220
    v_cvt_pk_bf16_f32 v117, v219, v220
    v_lshlrev_b32 v219, 16, v118
    v_and_b32 v220, 0xffff0000, v118
    v_mul_f32 v219, s30, v219
    v_mul_f32 v220, s30, v220
    v_cvt_pk_bf16_f32 v118, v219, v220
    v_lshlrev_b32 v219, 16, v119
    v_and_b32 v220, 0xffff0000, v119
    v_mul_f32 v219, s30, v219
    v_mul_f32 v220, s30, v220
    v_cvt_pk_bf16_f32 v119, v219, v220
    v_lshlrev_b32 v219, 16, v120
    v_and_b32 v220, 0xffff0000, v120
    v_mul_f32 v219, s30, v219
    v_mul_f32 v220, s30, v220
    v_cvt_pk_bf16_f32 v120, v219, v220
    v_lshlrev_b32 v219, 16, v121
    v_and_b32 v220, 0xffff0000, v121
    v_mul_f32 v219, s30, v219
    v_mul_f32 v220, s30, v220
    v_cvt_pk_bf16_f32 v121, v219, v220
    v_lshlrev_b32 v219, 16, v122
    v_and_b32 v220, 0xffff0000, v122
    v_mul_f32 v219, s30, v219
    v_mul_f32 v220, s30, v220
    v_cvt_pk_bf16_f32 v122, v219, v220
    v_lshlrev_b32 v219, 16, v123
    v_and_b32 v220, 0xffff0000, v123
    v_mul_f32 v219, s30, v219
    v_mul_f32 v220, s30, v220
    v_cvt_pk_bf16_f32 v123, v219, v220
    v_lshlrev_b32 v219, 4, v211
    s_lshl_b32 s28, s32, 10
    s_add_u32 s28, s28, 140544
    v_add_u32 v219, s28, v219
    ds_write_b128 v219, v[112:115]
    ds_write_b128 v219, v[116:119] offset:8192
    s_waitcnt lgkmcnt(2)
    v_mfma_f32_32x32x16_bf16 v[72:87], v[88:91], v[56:59], 0
    v_mfma_f32_32x32x16_bf16 v[72:87], v[92:95], v[60:63], v[72:87]
    v_mfma_f32_32x32x16_bf16 v[72:87], v[96:99], v[64:67], v[72:87]
    v_mfma_f32_32x32x16_bf16 v[72:87], v[100:103], v[68:71], v[72:87]
    s_cmp_ge_u32 s32, 4
    s_cbranch_scc1 B_NOWC
    ds_write_b128 v219, v[120:123] offset:16384
B_NOWC:
    v_lshlrev_b32 v223, 16, v223
    v_mul_f32 v223, s30, v223
    v_mul_u32_u24 v224, 112, v221
    s_lshr_b32 s28, s32, 2
    s_lshl_b32 s28, s28, 6
    v_lshl_add_u32 v224, v222, 3, v224
    v_add_u32 v224, s28, v224
    s_nop 1
    v_fma_f32 v72, v72, s30, v223
    v_fma_f32 v73, v73, s30, v223
    v_fma_f32 v74, v74, s30, v223
    v_fma_f32 v75, v75, s30, v223
    v_fma_f32 v76, v76, s30, v223
    v_fma_f32 v77, v77, s30, v223
    v_fma_f32 v78, v78, s30, v223
    v_fma_f32 v79, v79, s30, v223
    v_fma_f32 v80, v80, s30, v223
    v_fma_f32 v81, v81, s30, v223
    v_fma_f32 v82, v82, s30, v223
    v_fma_f32 v83, v83, s30, v223
    v_fma_f32 v84, v84, s30, v223
    v_fma_f32 v85, v85, s30, v223
    v_fma_f32 v86, v86, s30, v223
    v_fma_f32 v87, v87, s30, v223
    v_cvt_pk_bf16_f32 v88, v72, v73
    v_cvt_pk_bf16_f32 v89, v74, v75
    v_cvt_pk_bf16_f32 v90, v76, v77
    v_cvt_pk_bf16_f32 v91, v78, v79
    v_cvt_pk_bf16_f32 v92, v80, v81
    v_cvt_pk_bf16_f32 v93, v82, v83
    v_cvt_pk_bf16_f32 v94, v84, v85
    v_cvt_pk_bf16_f32 v95, v86, v87
    ds_write_b64 v224, v[88:89] offset:42752
    ds_write_b64 v224, v[90:91] offset:42768
    s_cmp_ge_u32 s32, 4
    s_cbranch_scc1 B_QDONE
    ds_write_b64 v224, v[92:93] offset:42784
    ds_write_b64 v224, v[94:95] offset:42800
B_QDONE:
    v_lshlrev_b32 v27, 4, v0
    v_add_u32 v30, 114944, v27
    v_mov_b32 v40, -1
    v_mov_b32 v41, -1
    v_mov_b32 v42, -1
    v_mov_b32 v43, -1
    v_mov_b32 v44, 0
    v_mov_b32 v45, 0
    v_mov_b32 v46, 0
    v_mov_b32 v47, 0
    ds_write_b128 v30, v[40:43] offset:0
    ds_write_b128 v30, v[40:43] offset:8192
    ds_write_b128 v30, v[40:43] offset:16384
    v_cmp_gt_u32 vcc, 208, v0
    s_nop 0
    s_and_saveexec_b64 s[24:25], vcc
    ds_write_b128 v27, v[44:47] offset:57088
    v_cmp_gt_u32 vcc, 64, v0
    s_nop 0
    s_and_b64 exec, exec, vcc
    ds_write_b128 v30, v[40:43] offset:24576
    v_cmp_gt_u32 vcc, 16, v0
    s_nop 0
    s_and_b64 exec, exec, vcc
    ds_write_b128 v27, v[44:47] offset:40960
    s_mov_b64 exec, s[24:25]
    ds_write_b128 v27, v[44:47] offset:0
    ds_write_b128 v27, v[44:47] offset:8192
    ds_write_b128 v27, v[44:47] offset:16384
    ds_write_b128 v27, v[44:47] offset:24576
    ds_write_b128 v27, v[44:47] offset:32768
    s_waitcnt lgkmcnt(0)
    s_barrier
    s_lshl_b32 s28, s2, 3
    s_add_u32 s28, s28, 0
    s_mov_b32 s46, 0x400000
    s_mov_b32 s47, 1
B_POLL:
    buffer_load_dwordx2 v[208:209], v4, s[12:15], s28 offen sc1
    s_waitcnt vmcnt(0)
    v_lshrrev_b32 v5, 24, v208
    v_cmp_ne_u32 vcc, s43, v209
    v_cmp_ne_u32 s[24:25], s45, v5
    s_nop 0
    s_or_b64 vcc, vcc, s[24:25]
    s_and_b64 exec, exec, vcc
    s_cbranch_execz B_POLLED
    s_sub_u32 s46, s46, 1
    s_cmp_eq_u32 s46, 0
    s_cbranch_scc1 B_END
    s_sleep 2
    s_branch B_POLL
B_POLLED:
    s_mov_b64 exec, -1
B_ROUND:
    v_bfe_u32 v215, v208, 12, 12
    v_mov_b32 v245, v215
    v_subrev_u32 v215, s41, v215
    v_min_i32 v215, s40, v215
    v_and_b32 v240, 1, v0
    v_lshlrev_b32 v240, 2, v240
    v_sub_u32 v215, v215, v240
    v_and_b32 v27, 0xfff, v208
    v_add3_u32 v27, v27, v214, v240
    v_add_u32 v27, s41, v27
    v_lshlrev_b32 v27, 2, v27
    v_mov_b32 v31, 0x7ffffff0
    s_mov_b32 s28, 524288
    v_cmp_lt_i32 vcc, 0, v215
    s_nop 1
    v_cndmask_b32 v30, v31, v27, vcc
    buffer_load_dwordx4 v[40:43], v30, s[12:15], s28 offen offset:0 sc1
    v_cmp_lt_i32 vcc, 8, v215
    s_nop 1
    v_cndmask_b32 v30, v31, v27, vcc
    buffer_load_dwordx4 v[44:47], v30, s[12:15], s28 offen offset:32 sc1
    v_cmp_lt_i32 vcc, 16, v215
    s_nop 1
    v_cndmask_b32 v30, v31, v27, vcc
    buffer_load_dwordx4 v[48:51], v30, s[12:15], s28 offen offset:64 sc1
    v_cmp_lt_i32 vcc, 24, v215
    s_nop 1
    v_cndmask_b32 v30, v31, v27, vcc
    buffer_load_dwordx4 v[52:55], v30, s[12:15], s28 offen offset:96 sc1
    s_cmp_eq_u32 s47, 0
    s_cbranch_scc1 B_NOTFIRST
    s_mov_b32 s4, s48
    s_and_b32 s5, s49, 0xffff
    s_or_b32 s5, s5, 0x800000
    s_mov_b32 s6, 10000
    s_mov_b32 s7, 0x20000
    s_mov_b32 s8, s50
    s_and_b32 s9, s51, 0xffff
    s_or_b32 s9, s9, 0x200000
    s_mov_b32 s10, 640000
    s_mov_b32 s11, 0x20000
    v_add_u32 v212, s35, v211
    v_and_b32 v212, 63, v212
    v_lshlrev_b32 v212, 2, v212
    v_and_b32 v119, 15, v211
    v_lshlrev_b32 v119, 5, v119
    v_add_u32 v119, 65023, v119
    v_lshlrev_b32 v213, 16, v119
    v_and_b32 v112, 31, v211
    v_lshrrev_b32 v113, 5, v211
    v_bfe_u32 v114, v211, 1, 3
    v_lshlrev_b32 v115, 7, v112
    v_add_u32 v115, s36, v115
    v_or_b32 v116, 0, v113
    v_xor_b32 v116, v116, v114
    v_lshl_add_u32 v6, v116, 4, v115
    v_or_b32 v116, 2, v113
    v_xor_b32 v116, v116, v114
    v_lshl_add_u32 v7, v116, 4, v115
    v_or_b32 v116, 4, v113
    v_xor_b32 v116, v116, v114
    v_lshl_add_u32 v8, v116, 4, v115
    v_or_b32 v116, 6, v113
    v_xor_b32 v116, v116, v114
    v_lshl_add_u32 v9, v116, 4, v115
    v_lshlrev_b32 v10, 4, v211
    v_add_u32 v10, s36, v10
    v_add_u32 v10, 0x1000, v10
    v_mul_u32_u24 v12, 112, v112
    v_lshl_add_u32 v12, v113, 4, v12
    v_add_u32 v12, 42752, v12
    v_xor_b32 v13, 1, v113
    v_lshlrev_b32 v13, 13, v13
    v_lshlrev_b32 v14, 3, v112
    v_lshlrev_b32 v241, 4, v113
    v_and_b32 v116, 7, v211
    v_lshrrev_b32 v117, 4, v211
    v_xor_b32 v118, v116, v117
    v_lshlrev_b32 v17, 4, v118
    v_mov_b32 v21, v17
    v_xor_b32 v118, 4, v118
    v_lshlrev_b32 v19, 4, v118
    v_mov_b32 v23, v19
    v_lshlrev_b32 v25, 4, v113
    v_bfe_u32 v116, v211, 3, 1
    v_bfe_u32 v117, v211, 4, 1
    v_lshlrev_b32 v118, 4, v113
    v_lshl_add_u32 v118, v116, 2, v118
    v_add_u32 v118, v118, v117
    v_lshlrev_b32 v242, 3, v118
    v_bfe_u32 v116, v211, 2, 1
    v_lshlrev_b32 v118, 4, v116
    v_bfe_u32 v116, v211, 4, 1
    v_lshl_add_u32 v118, v116, 3, v118
    v_and_b32 v116, 1, v211
    v_lshl_add_u32 v118, v116, 2, v118
    v_bfe_u32 v116, v211, 3, 1
    v_lshl_add_u32 v118, v116, 1, v118
    v_bfe_u32 v116, v211, 1, 1
    v_add_u32 v118, v118, v116
    v_lshlrev_b32 v244, 3, v118
    v_add_u32 v243, 4, v244
    v_add_u32 v244, 2, v244
    v_lshlrev_b32 v1, 4, v211
    v_add_u32 v1, 140544, v1
    ds_read_b128 v[144:147], v1 offset:0
    ds_read_b128 v[148:151], v1 offset:1024
    ds_read_b128 v[152:155], v1 offset:2048
    ds_read_b128 v[156:159], v1 offset:3072
    ds_read_b128 v[160:163], v1 offset:4096
    ds_read_b128 v[164:167], v1 offset:5120
    ds_read_b128 v[168:171], v1 offset:6144
    ds_read_b128 v[172:175], v1 offset:7168
    ds_read_b128 v[176:179], v1 offset:8192
    ds_read_b128 v[180:183], v1 offset:9216
    ds_read_b128 v[184:187], v1 offset:10240
    ds_read_b128 v[188:191], v1 offset:11264
    ds_read_b128 v[192:195], v1 offset:12288
    ds_read_b128 v[196:199], v1 offset:13312
    ds_read_b128 v[200:203], v1 offset:14336
    ds_read_b128 v[204:207], v1 offset:15360
    ds_read_b128 v[128:131], v1 offset:16384
    ds_read_b128 v[132:135], v1 offset:17408
    ds_read_b128 v[136:139], v1 offset:18432
    ds_read_b128 v[140:143], v1 offset:19456
    s_mov_b32 s47, 0
    s_branch B_COUNT
B_NOTFIRST:
    s_waitcnt lgkmcnt(0)
    s_barrier
B_COUNT:
    v_mov_b32 v246, 42496
    ds_max_u32 v246, v245
    v_mov_b32 v240, 1
    s_lshl_b32 s28, s35, 2
    s_mov_b32 s10, 640000
    s_waitcnt vmcnt(0)
    v_lshrrev_b32 v72, 24, v40
    v_and_b32 v72, 0xfc, v72
    v_lshrrev_b32 v73, 24, v41
    v_and_b32 v73, 0xfc, v73
    v_lshrrev_b32 v74, 24, v42
    v_and_b32 v74, 0xfc, v74
    v_lshrrev_b32 v75, 24, v43
    v_and_b32 v75, 0xfc, v75
    v_lshrrev_b32 v76, 24, v44
    v_and_b32 v76, 0xfc, v76
    v_lshrrev_b32 v77, 24, v45
    v_and_b32 v77, 0xfc, v77
    v_lshrrev_b32 v78, 24, v46
    v_and_b32 v78, 0xfc, v78
    v_lshrrev_b32 v79, 24, v47
    v_and_b32 v79, 0xfc, v79
    v_cmpx_lt_i32 vcc, 0, v215
    s_cbranch_execz B_COUNTED
    ds_add_rtn_u32 v56, v72, v240 offset:40960
    v_subrev_u32 v246, s28, v72
    v_bfe_u32 v247, v40, 14, 12
    v_cmp_gt_u32 vcc, 12, v246
    v_add_u32 v247, v214, v247
    s_and_saveexec_b64 s[24:25], vcc
    buffer_load_dword v252, v247, s[8:11], 0 idxen
    s_mov_b64 exec, s[24:25]
    v_cmpx_lt_i32 vcc, 1, v215
    ds_add_rtn_u32 v57, v73, v240 offset:40960
    v_subrev_u32 v246, s28, v73
    v_bfe_u32 v247, v41, 14, 12
    v_cmp_gt_u32 vcc, 12, v246
    v_add_u32 v247, v214, v247
    s_and_saveexec_b64 s[24:25], vcc
    buffer_load_dword v252, v247, s[8:11], 0 idxen
    s_mov_b64 exec, s[24:25]
    v_cmpx_lt_i32 vcc, 2, v215
    s_cbranch_execz B_COUNTED
    ds_add_rtn_u32 v58, v74, v240 offset:40960
    v_subrev_u32 v246, s28, v74
    v_bfe_u32 v247, v42, 14, 12
    v_cmp_gt_u32 vcc, 12, v246
    v_add_u32 v247, v214, v247
    s_and_saveexec_b64 s[24:25], vcc
    buffer_load_dword v252, v247, s[8:11], 0 idxen
    s_mov_b64 exec, s[24:25]
    v_cmpx_lt_i32 vcc, 3, v215
    ds_add_rtn_u32 v59, v75, v240 offset:40960
    v_subrev_u32 v246, s28, v75
    v_bfe_u32 v247, v43, 14, 12
    v_cmp_gt_u32 vcc, 12, v246
    v_add_u32 v247, v214, v247
    s_and_saveexec_b64 s[24:25], vcc
    buffer_load_dword v252, v247, s[8:11], 0 idxen
    s_mov_b64 exec, s[24:25]
    v_cmpx_lt_i32 vcc, 8, v215
    s_cbranch_execz B_COUNTED
    ds_add_rtn_u32 v60, v76, v240 offset:40960
    v_subrev_u32 v246, s28, v76
    v_bfe_u32 v247, v44, 14, 12
    v_cmp_gt_u32 vcc, 12, v246
    v_add_u32 v247, v214, v247
    s_and_saveexec_b64 s[24:25], vcc
    buffer_load_dword v252, v247, s[8:11], 0 idxen
    s_mov_b64 exec, s[24:25]
    v_cmpx_lt_i32 vcc, 9, v215
    ds_add_rtn_u32 v61, v77, v240 offset:40960
    v_subrev_u32 v246, s28, v77
    v_bfe_u32 v247, v45, 14, 12
    v_cmp_gt_u32 vcc, 12, v246
    v_add_u32 v247, v214, v247
    s_and_saveexec_b64 s[24:25], vcc
    buffer_load_dword v252, v247, s[8:11], 0 idxen
    s_mov_b64 exec, s[24:25]
    v_cmpx_lt_i32 vcc, 10, v215
    s_cbranch_execz B_COUNTED
    ds_add_rtn_u32 v62, v78, v240 offset:40960
    v_subrev_u32 v246, s28, v78
    v_bfe_u32 v247, v46, 14, 12
    v_cmp_gt_u32 vcc, 12, v246
    v_add_u32 v247, v214, v247
    s_and_saveexec_b64 s[24:25], vcc
    buffer_load_dword v252, v247, s[8:11], 0 idxen
    s_mov_b64 exec, s[24:25]
    v_cmpx_lt_i32 vcc, 11, v215
    ds_add_rtn_u32 v63, v79, v240 offset:40960
    v_subrev_u32 v246, s28, v79
    v_bfe_u32 v247, v47, 14, 12
    v_cmp_gt_u32 vcc, 12, v246
    v_add_u32 v247, v214, v247
    s_and_saveexec_b64 s[24:25], vcc
    buffer_load_dword v252, v247, s[8:11], 0 idxen
    s_mov_b64 exec, s[24:25]
    v_lshrrev_b32 v80, 24, v48
    v_and_b32 v80, 0xfc, v80
    v_lshrrev_b32 v81, 24, v49
    v_and_b32 v81, 0xfc, v81
    v_lshrrev_b32 v82, 24, v50
    v_and_b32 v82, 0xfc, v82
    v_lshrrev_b32 v83, 24, v51
    v_and_b32 v83, 0xfc, v83
    v_cmpx_lt_i32 vcc, 16, v215
    s_cbranch_execz B_COUNTED
    ds_add_rtn_u32 v64, v80, v240 offset:40960
    v_cmpx_lt_i32 vcc, 17, v215
    ds_add_rtn_u32 v65, v81, v240 offset:40960
    v_cmpx_lt_i32 vcc, 18, v215
    s_cbranch_execz B_COUNTED
    ds_add_rtn_u32 v66, v82, v240 offset:40960
    v_cmpx_lt_i32 vcc, 19, v215
    ds_add_rtn_u32 v67, v83, v240 offset:40960
    v_lshrrev_b32 v84, 24, v52
    v_and_b32 v84, 0xfc, v84
    v_lshrrev_b32 v85, 24, v53
    v_and_b32 v85, 0xfc, v85
    v_lshrrev_b32 v86, 24, v54
    v_and_b32 v86, 0xfc, v86
    v_lshrrev_b32 v87, 24, v55
    v_and_b32 v87, 0xfc, v87
    v_cmpx_lt_i32 vcc, 24, v215
    s_cbranch_execz B_COUNTED
    ds_add_rtn_u32 v68, v84, v240 offset:40960
    v_cmpx_lt_i32 vcc, 25, v215
    ds_add_rtn_u32 v69, v85, v240 offset:40960
    v_cmpx_lt_i32 vcc, 26, v215
    s_cbranch_execz B_COUNTED
    ds_add_rtn_u32 v70, v86, v240 offset:40960
    v_cmpx_lt_i32 vcc, 27, v215
    ds_add_rtn_u32 v71, v87, v240 offset:40960
B_COUNTED:
    s_mov_b64 exec, -1
    s_waitcnt lgkmcnt(0)
    s_barrier
    v_mov_b32 v30, 0
    ds_read_b32 v27, v212 offset:40960
    ds_read_b32 v30, v30 offset:42496
    v_cmp_gt_u32 vcc, s34, v211
    s_waitcnt lgkmcnt(0)
    v_readfirstlane_b32 s42, v30
    v_add_u32 v88, 3, v27
    v_lshrrev_b32 v88, 2, v88
    v_max_u32 v88, 1, v88
    v_cndmask_b32 v88, 0, v88, vcc
    v_mov_b32 v89, v88
    s_nop 1
    v_add_u32_dpp v89, v89, v89 row_shr:1 row_mask:0xf bank_mask:0xf
    s_nop 1
    v_add_u32_dpp v89, v89, v89 row_shr:2 row_mask:0xf bank_mask:0xf
    s_nop 1
    v_add_u32_dpp v89, v89, v89 row_shr:4 row_mask:0xf bank_mask:0xf
    s_nop 1
    v_add_u32_dpp v89, v89, v89 row_shr:8 row_mask:0xf bank_mask:0xf
    s_nop 1
    v_add_u32_dpp v89, v89, v89 row_bcast:15 row_mask:0xa bank_mask:0xf
    s_nop 1
    v_add_u32_dpp v89, v89, v89 row_bcast:31 row_mask:0xc bank_mask:0xf
    s_nop 0
    v_readlane_b32 s44, v89, 63
    v_sub_u32 v92, v89, v88
    v_lshlrev_b32 v92, 2, v92
    v_mov_b32 v93, v213
    v_lshlrev_b32 v94, 10, v211
    s_cmp_gt_u32 s44, 768
    s_cbranch_scc1 B_OVERFLOW
    s_and_saveexec_b64 s[24:25], vcc
    v_add_u32 v210, v210, v27
    v_lshlrev_b32 v27, 1, v212
    ds_write_b64 v27, v[92:93] offset:41216
    s_mov_b64 exec, s[24:25]
    v_mov_b32 v27, s32
    v_lshl_add_u32 v30, v27, 2, v92
B_QFILL:
    v_cmpx_lt_u32 vcc, v27, v88
    s_cbranch_execz B_QFILLED
    ds_write_b32 v30, v94 offset:57088
    v_add_u32 v27, 8, v27
    v_add_u32 v30, 32, v30
    s_branch B_QFILL
B_QFILLED:
    s_mov_b64 exec, -1
    v_mov_b32 v240, 114944
    s_mov_b32 s30, 115968
    s_mov_b32 s10, 640000
    s_mov_b32 s31, 0x3fff
    s_waitcnt lgkmcnt(0)
    v_lshlrev_b32 v27, 1, v72
    ds_read_b64 v[96:97], v27 offset:41216
    v_lshlrev_b32 v27, 1, v73
    ds_read_b64 v[100:101], v27 offset:41216
    v_lshlrev_b32 v27, 1, v74
    ds_read_b64 v[104:105], v27 offset:41216
    v_lshlrev_b32 v27, 1, v75
    ds_read_b64 v[108:109], v27 offset:41216
    v_lshlrev_b32 v27, 1, v76
    ds_read_b64 v[112:113], v27 offset:41216
    v_lshlrev_b32 v27, 1, v77
    ds_read_b64 v[116:117], v27 offset:41216
    v_lshlrev_b32 v27, 1, v78
    ds_read_b64 v[120:121], v27 offset:41216
    v_lshlrev_b32 v27, 1, v79
    ds_read_b64 v[124:125], v27 offset:41216
    s_waitcnt lgkmcnt(0)
    v_cmpx_lt_i32 vcc, 0, v215
    s_cbranch_execz B_SC1
    v_add_u32 v96, v96, v56
    v_and_or_b32 v98, v40, s31, v97
    v_bfe_u32 v99, v40, 14, 12
    v_lshl_add_u32 v96, v96, 3, v240
    v_add_u32 v99, v214, v99
    ds_write_b64 v96, v[98:99]
    v_cmpx_lt_i32 vcc, 1, v215
    v_add_u32 v100, v100, v57
    v_and_or_b32 v102, v41, s31, v101
    v_bfe_u32 v103, v41, 14, 12
    v_lshl_add_u32 v100, v100, 3, v240
    v_add_u32 v103, v214, v103
    ds_write_b64 v100, v[102:103]
    v_cmpx_lt_i32 vcc, 2, v215
    s_cbranch_execz B_SC1
    v_add_u32 v104, v104, v58
    v_and_or_b32 v106, v42, s31, v105
    v_bfe_u32 v107, v42, 14, 12
    v_lshl_add_u32 v104, v104, 3, v240
    v_add_u32 v107, v214, v107
    ds_write_b64 v104, v[106:107]
    v_cmpx_lt_i32 vcc, 3, v215
    v_add_u32 v108, v108, v59
    v_and_or_b32 v110, v43, s31, v109
    v_bfe_u32 v111, v43, 14, 12
    v_lshl_add_u32 v108, v108, 3, v240
    v_add_u32 v111, v214, v111
    ds_write_b64 v108, v[110:111]
    v_cmpx_lt_i32 vcc, 8, v215
    s_cbranch_execz B_SC1
    v_add_u32 v112, v112, v60
    v_and_or_b32 v114, v44, s31, v113
    v_bfe_u32 v115, v44, 14, 12
    v_lshl_add_u32 v112, v112, 3, v240
    v_add_u32 v115, v214, v115
    ds_write_b64 v112, v[114:115]
    v_cmpx_lt_i32 vcc, 9, v215
    v_add_u32 v116, v116, v61
    v_and_or_b32 v118, v45, s31, v117
    v_bfe_u32 v119, v45, 14, 12
    v_lshl_add_u32 v116, v116, 3, v240
    v_add_u32 v119, v214, v119
    ds_write_b64 v116, v[118:119]
    v_cmpx_lt_i32 vcc, 10, v215
    s_cbranch_execz B_SC1
    v_add_u32 v120, v120, v62
    v_and_or_b32 v122, v46, s31, v121
    v_bfe_u32 v123, v46, 14, 12
    v_lshl_add_u32 v120, v120, 3, v240
    v_add_u32 v123, v214, v123
    ds_write_b64 v120, v[122:123]
    v_cmpx_lt_i32 vcc, 11, v215
    v_add_u32 v124, v124, v63
    v_and_or_b32 v126, v47, s31, v125
    v_bfe_u32 v127, v47, 14, 12
    v_lshl_add_u32 v124, v124, 3, v240
    v_add_u32 v127, v214, v127
    ds_write_b64 v124, v[126:127]
B_SC1:
    s_mov_b64 exec, -1
    v_cmp_lt_i32 vcc, 16, v215
    s_cbranch_vccz B_SC3
    v_cmpx_lt_i32 vcc, 16, v215
    v_lshlrev_b32 v27, 1, v80
    ds_read_b64 v[96:97], v27 offset:41216
    v_lshlrev_b32 v27, 1, v81
    ds_read_b64 v[100:101], v27 offset:41216
    v_lshlrev_b32 v27, 1, v82
    ds_read_b64 v[104:105], v27 offset:41216
    v_lshlrev_b32 v27, 1, v83
    ds_read_b64 v[108:109], v27 offset:41216
    s_waitcnt lgkmcnt(0)
    v_cmpx_lt_i32 vcc, 16, v215
    s_cbranch_execz B_SC2
    v_add_u32 v96, v96, v64
    v_and_or_b32 v98, v48, s31, v97
    v_bfe_u32 v99, v48, 14, 12
    v_lshl_add_u32 v96, v96, 3, v240
    v_add_u32 v99, v214, v99
    ds_write_b64 v96, v[98:99]
    v_cmpx_lt_i32 vcc, 17, v215
    v_add_u32 v100, v100, v65
    v_and_or_b32 v102, v49, s31, v101
    v_bfe_u32 v103, v49, 14, 12
    v_lshl_add_u32 v100, v100, 3, v240
    v_add_u32 v103, v214, v103
    ds_write_b64 v100, v[102:103]
    v_cmpx_lt_i32 vcc, 18, v215
    s_cbranch_execz B_SC2
    v_add_u32 v104, v104, v66
    v_and_or_b32 v106, v50, s31, v105
    v_bfe_u32 v107, v50, 14, 12
    v_lshl_add_u32 v104, v104, 3, v240
    v_add_u32 v107, v214, v107
    ds_write_b64 v104, v[106:107]
    v_cmpx_lt_i32 vcc, 19, v215
    v_add_u32 v108, v108, v67
    v_and_or_b32 v110, v51, s31, v109
    v_bfe_u32 v111, v51, 14, 12
    v_lshl_add_u32 v108, v108, 3, v240
    v_add_u32 v111, v214, v111
    ds_write_b64 v108, v[110:111]
B_SC2:
    s_mov_b64 exec, -1
    v_cmp_lt_i32 vcc, 24, v215
    s_cbranch_vccz B_SC3
    v_cmpx_lt_i32 vcc, 24, v215
    v_lshlrev_b32 v27, 1, v84
    ds_read_b64 v[96:97], v27 offset:41216
    v_lshlrev_b32 v27, 1, v85
    ds_read_b64 v[100:101], v27 offset:41216
    v_lshlrev_b32 v27, 1, v86
    ds_read_b64 v[104:105], v27 offset:41216
    v_lshlrev_b32 v27, 1, v87
    ds_read_b64 v[108:109], v27 offset:41216
    s_waitcnt lgkmcnt(0)
    v_cmpx_lt_i32 vcc, 24, v215
    s_cbranch_execz B_SC3
    v_add_u32 v96, v96, v68
    v_and_or_b32 v98, v52, s31, v97
    v_bfe_u32 v99, v52, 14, 12
    v_lshl_add_u32 v96, v96, 3, v240
    v_add_u32 v99, v214, v99
    ds_write_b64 v96, v[98:99]
    v_cmpx_lt_i32 vcc, 25, v215
    v_add_u32 v100, v100, v69
    v_and_or_b32 v102, v53, s31, v101
    v_bfe_u32 v103, v53, 14, 12
    v_lshl_add_u32 v100, v100, 3, v240
    v_add_u32 v103, v214, v103
    ds_write_b64 v100, v[102:103]
    v_cmpx_lt_i32 vcc, 26, v215
    s_cbranch_execz B_SC3
    v_add_u32 v104, v104, v70
    v_and_or_b32 v106, v54, s31, v105
    v_bfe_u32 v107, v54, 14, 12
    v_lshl_add_u32 v104, v104, 3, v240
    v_add_u32 v107, v214, v107
    ds_write_b64 v104, v[106:107]
    v_cmpx_lt_i32 vcc, 27, v215
    v_add_u32 v108, v108, v71
    v_and_or_b32 v110, v55, s31, v109
    v_bfe_u32 v111, v55, 14, 12
    v_lshl_add_u32 v108, v108, 3, v240
    v_add_u32 v111, v214, v111
    ds_write_b64 v108, v[110:111]
B_SC3:
    s_mov_b64 exec, -1
    s_add_u32 s28, s44, 7
    s_lshr_b32 s28, s28, 3
    s_lshr_b32 s29, s28, 3
    s_and_b32 s30, s28, 7
    s_mul_i32 s38, s29, s32
    s_min_u32 s37, s32, s30
    s_add_u32 s38, s38, s37
    s_cmp_lt_u32 s32, s30
    s_cselect_b32 s37, 1, 0
    s_add_u32 s37, s37, s29
    s_cmp_lt_u32 s29, 3
    s_cbranch_scc1 B_NOSKEW
    s_min_u32 s30, s32, 4
    s_sub_u32 s31, s32, s30
    s_sub_u32 s30, s30, s31
    s_mul_i32 s30, s30, 1
    s_add_u32 s38, s38, s30
    s_cmp_lt_u32 s32, 4
    s_cselect_b32 s30, 1, 4294967295
    s_add_u32 s37, s37, s30
B_NOSKEW:
    s_add_u32 s30, s44, 7
    s_lshr_b32 s30, s30, 6
    s_add_u32 s29, s38, 7
    s_sub_u32 s29, s29, s32
    s_sub_u32 s29, s29, s32
    s_cmp_ge_u32 s30, 3
    s_cselect_b32 s3, s29, 0
    s_cselect_b32 s38, s32, s38
    s_mul_i32 s28, s38, 256
    s_add_u32 s28, s28, 114944
    v_add_u32 v1, s28, v242
    v_add_u32 v2, s28, v243
    v_add_u32 v3, s28, v244
    s_lshl_b32 s28, s38, 5
    s_add_u32 s28, s28, 57088
    v_mov_b32 v5, s28
    v_add_u32 v4, s28, v241
    s_waitcnt lgkmcnt(0)
    s_barrier
    s_cmp_eq_u32 s37, 0
    s_cbranch_scc1 B_NOTILES
    s_cmp_lg_u32 s39, 0
    s_cbranch_scc1 B_SAFE
    s_setprio 3
    ds_read_u16 v16, v1 offset:0
    ds_read_u16 v18, v1 offset:16
    ds_read_u16 v20, v1 offset:64
    ds_read_u16 v22, v1 offset:80
    ds_read_b32 v24, v2 offset:0
    ds_read_b128 v[32:35], v4 offset:0
    ds_read_b32 v26, v5 offset:0
    ds_read_u16 v15, v3 offset:0
    s_mul_i32 s24, s3, 256
    s_lshl_b32 s25, s3, 5
    v_add_u32 v1, s24, v1
    v_add_u32 v2, s24, v2
    v_add_u32 v3, s24, v3
    v_add_u32 v4, s25, v4
    v_add_u32 v5, s25, v5
    s_mov_b32 s6, 10000
    s_mov_b32 s10, 640000
    s_waitcnt lgkmcnt(0)
    s_add_u32 m0, s36, 0
    s_nop 0
    buffer_load_dwordx4 v[16:17], s[4:7], 0 idxen offen lds
    s_add_u32 m0, s36, 1024
    s_nop 0
    buffer_load_dwordx4 v[18:19], s[4:7], 0 idxen offen lds
    s_add_u32 m0, s36, 2048
    s_nop 0
    buffer_load_dwordx4 v[20:21], s[4:7], 0 idxen offen lds
    s_add_u32 m0, s36, 3072
    s_nop 0
    buffer_load_dwordx4 v[22:23], s[4:7], 0 idxen offen lds
    buffer_load_dwordx4 v[104:107], v[24:25], s[8:11], 0 idxen offen
    ds_read_b32 v24, v2 offset:256
    v_add_u32 v27, v26, v13
    v_lshrrev_b32 v27, 14, v27
    v_lshl_add_u32 v11, v27, 5, v12
    v_add_u32 v15, v15, v241
    ds_read_b128 v[112:115], v11 offset:0
    ds_read_b128 v[116:119], v11 offset:3584
    ds_read_b128 v[120:123], v11 offset:7168
    ds_read_b128 v[124:127], v11 offset:10752
    ds_read_u16 v16, v1 offset:256
    ds_read_u16 v18, v1 offset:272
    ds_read_u16 v20, v1 offset:320
    ds_read_u16 v22, v1 offset:336
    v_mov_b32 v216, 1.0
    v_mov_b32 v220, 0
    v_mov_b32 v217, 1.0
    v_mov_b32 v221, 0
    v_mov_b32 v218, 1.0
    v_mov_b32 v222, 0
    v_mov_b32 v219, 1.0
    v_mov_b32 v223, 0
    v_mov_b32 v224, 1.0
    v_mov_b32 v228, 0
    v_mov_b32 v225, 1.0
    v_mov_b32 v229, 0
    v_mov_b32 v226, 1.0
    v_mov_b32 v230, 0
    v_mov_b32 v227, 1.0
    v_mov_b32 v231, 0
    v_mov_b32 v36, v14
    v_mov_b32 v37, v14
    v_mov_b32 v38, v14
    v_mov_b32 v39, v14
    v_cmp_ne_u32 vcc, v32, v35
    s_mov_b32 s30, 0
    s_cmp_eq_u64 vcc, 0
    s_cselect_b32 s29, 1, 0
    s_waitcnt vmcnt(0)
    ds_read_b128 v[88:91], v6
    ds_read_b128 v[92:95], v7
    ds_read_b128 v[96:99], v8
    ds_read_b128 v[100:103], v9
    ds_read_b128 v[108:111], v15 offset:1
    s_waitcnt lgkmcnt(0)
    s_cmp_ge_u32 s37, 2
    s_cselect_b32 s6, 10000, 0
    s_cselect_b32 s10, 640000, 0
    s_add_u32 m0, s36, 0
    s_nop 0
    buffer_load_dwordx4 v[16:17], s[4:7], 0 idxen offen lds
    s_add_u32 m0, s36, 1024
    s_nop 0
    buffer_load_dwordx4 v[18:19], s[4:7], 0 idxen offen lds
    s_add_u32 m0, s36, 2048
    s_nop 0
    buffer_load_dwordx4 v[20:21], s[4:7], 0 idxen offen lds
    s_add_u32 m0, s36, 3072
    s_nop 0
    buffer_load_dwordx4 v[22:23], s[4:7], 0 idxen offen lds
    buffer_load_dwordx4 v[248:251], v[24:25], s[8:11], 0 idxen offen
    v_mfma_f32_32x32x16_bf16 v[56:71], v[88:91], v[144:147], 0
    v_mfma_f32_32x32x16_bf16 v[56:71], v[92:95], v[160:163], v[56:71]
    v_mfma_f32_32x32x16_bf16 v[56:71], v[96:99], v[176:179], v[56:71]
    v_mfma_f32_32x32x16_bf16 v[56:71], v[100:103], v[192:195], v[56:71]
    v_mfma_f32_32x32x16_bf16 v[56:71], v[104:107], v[128:131], v[56:71]
    v_mfma_f32_32x32x16_bf16 v[56:71], v[108:111], v[112:115], v[56:71]
    s_cmp_le_u32 s37, 1
    s_cbranch_scc0 B_W2PF
    s_mov_b32 s16, s60
    s_and_b32 s17, s61, 0xffff
    s_mov_b32 s18, 16384
    s_mov_b32 s19, 0x20000
    v_lshlrev_b32 v247, 4, v211
    s_lshl_b32 s24, s32, 11
    s_add_u32 m0, s24, 140544
    s_add_u32 s25, s24, 0
    buffer_load_dwordx4 v247, s[16:19], s25 offen lds
    s_add_u32 m0, s24, 141568
    s_add_u32 s25, s24, 1024
    buffer_load_dwordx4 v247, s[16:19], s25 offen lds
    s_mov_b32 s16, s62
    s_and_b32 s17, s63, 0xffff
    s_mov_b32 s18, 128
    s_mov_b32 s19, 0x20000
    s_mov_b32 m0, 156928
    s_nop 0
    buffer_load_dwordx4 v247, s[16:19], 0 offen lds
B_W2PF:
    s_setprio 2
    s_nop 7
    s_nop 3
    s_cmp_eq_u32 s29, 0
    s_cbranch_scc0 B_T001
B_T000:
    v_mfma_f32_32x32x16_bf16 v[72:87], v[88:91], v[148:151], 0
    v_rcp_f32 v224, v224
    v_rcp_f32 v225, v225
    v_rcp_f32 v226, v226
    v_rcp_f32 v227, v227
    v_mfma_f32_32x32x16_bf16 v[72:87], v[92:95], v[164:167], v[72:87]
    v_exp_f32 v40, v56
    v_exp_f32 v41, v57
    v_exp_f32 v42, v58
    ds_read_b32 v26, v5 offset:32
    ds_read_u16 v15, v3 offset:256
    v_mfma_f32_32x32x16_bf16 v[72:87], v[96:99], v[180:183], v[72:87]
    v_exp_f32 v43, v59
    v_exp_f32 v44, v60
    v_exp_f32 v45, v61
    v_add_u32 v32, v32, v14
    v_add_u32 v33, v33, v14
    v_add_u32 v34, v34, v14
    v_add_u32 v35, v35, v14
    v_mfma_f32_32x32x16_bf16 v[72:87], v[100:103], v[196:199], v[72:87]
    v_exp_f32 v46, v62
    v_exp_f32 v47, v63
    v_exp_f32 v48, v64
    v_mfma_f32_32x32x16_bf16 v[72:87], v[104:107], v[132:135], v[72:87]
    v_exp_f32 v49, v65
    v_exp_f32 v50, v66
    v_exp_f32 v51, v67
    v_mfma_f32_32x32x16_bf16 v[72:87], v[108:111], v[116:119], v[72:87]
    v_exp_f32 v52, v68
    v_exp_f32 v53, v69
    v_exp_f32 v54, v70
    v_exp_f32 v55, v71
    v_cvt_f64_f32 v[232:233], v220
    v_cvt_f64_f32 v[234:235], v221
    v_cvt_f64_f32 v[236:237], v222
    v_cvt_f64_f32 v[238:239], v223
    ds_add_f64 v36, v[232:233] offset:512
    ds_add_f64 v37, v[234:235] offset:512
    ds_add_f64 v38, v[236:237] offset:512
    ds_add_f64 v39, v[238:239] offset:512
    v_pk_mul_f32 v[228:229], v[228:229], v[224:225]
    v_pk_mul_f32 v[230:231], v[230:231], v[226:227]
    v_pk_fma_f32 v[56:57], v[56:57], v[42:43], v[56:57]
    v_pk_fma_f32 v[64:65], v[64:65], v[50:51], v[64:65]
    v_pk_add_f32 v[40:41], v[40:41], 1.0 op_sel_hi:[1,0]
    v_pk_add_f32 v[48:49], v[48:49], 1.0 op_sel_hi:[1,0]
    v_pk_fma_f32 v[56:57], v[58:59], v[40:41], v[56:57]
    v_pk_fma_f32 v[64:65], v[66:67], v[48:49], v[64:65]
    v_pk_fma_f32 v[40:41], v[40:41], v[42:43], v[40:41]
    v_pk_fma_f32 v[48:49], v[48:49], v[50:51], v[48:49]
    v_pk_fma_f32 v[56:57], v[56:57], v[44:45], v[56:57]
    v_pk_fma_f32 v[64:65], v[64:65], v[52:53], v[64:65]
    v_pk_fma_f32 v[56:57], v[60:61], v[40:41], v[56:57]
    v_pk_fma_f32 v[64:65], v[68:69], v[48:49], v[64:65]
    v_pk_fma_f32 v[40:41], v[40:41], v[44:45], v[40:41]
    v_pk_fma_f32 v[48:49], v[48:49], v[52:53], v[48:49]
    v_pk_fma_f32 v[56:57], v[56:57], v[46:47], v[56:57]
    v_pk_fma_f32 v[64:65], v[64:65], v[54:55], v[64:65]
    v_pk_fma_f32 v[220:221], v[62:63], v[40:41], v[56:57]
    v_pk_fma_f32 v[222:223], v[70:71], v[48:49], v[64:65]
    v_pk_fma_f32 v[216:217], v[40:41], v[46:47], v[40:41]
    v_pk_fma_f32 v[218:219], v[48:49], v[54:55], v[48:49]
    v_pk_fma_f32 v[28:29], v[216:217], v[218:219], v[28:29]
    s_waitcnt lgkmcnt(4)
    v_mfma_f32_32x32x16_bf16 v[56:71], v[88:91], v[152:155], 0
    v_rcp_f32 v216, v216
    v_rcp_f32 v217, v217
    v_rcp_f32 v218, v218
    v_rcp_f32 v219, v219
    v_mfma_f32_32x32x16_bf16 v[56:71], v[92:95], v[168:171], v[56:71]
    v_exp_f32 v40, v72
    v_exp_f32 v41, v73
    v_exp_f32 v42, v74
    v_add_u32 v27, v26, v13
    v_lshrrev_b32 v27, 14, v27
    v_lshl_add_u32 v11, v27, 5, v12
    v_add_u32 v15, v15, v241
    ds_read_b128 v[112:115], v11 offset:0
    ds_read_b128 v[116:119], v11 offset:3584
    v_mfma_f32_32x32x16_bf16 v[56:71], v[96:99], v[184:187], v[56:71]
    v_exp_f32 v43, v75
    v_exp_f32 v44, v76
    v_exp_f32 v45, v77
    ds_read_u16 v16, v1 offset:512
    ds_read_u16 v18, v1 offset:528
    ds_read_u16 v20, v1 offset:576
    ds_read_u16 v22, v1 offset:592
    ds_read_b32 v24, v2 offset:512
    v_mfma_f32_32x32x16_bf16 v[56:71], v[100:103], v[200:203], v[56:71]
    v_exp_f32 v46, v78
    v_exp_f32 v47, v79
    v_exp_f32 v48, v80
    v_mfma_f32_32x32x16_bf16 v[56:71], v[104:107], v[136:139], v[56:71]
    v_exp_f32 v49, v81
    v_exp_f32 v50, v82
    v_exp_f32 v51, v83
    v_mfma_f32_32x32x16_bf16 v[56:71], v[108:111], v[120:123], v[56:71]
    v_exp_f32 v52, v84
    v_exp_f32 v53, v85
    v_exp_f32 v54, v86
    v_exp_f32 v55, v87
    v_cvt_f64_f32 v[232:233], v228
    v_cvt_f64_f32 v[234:235], v229
    v_cvt_f64_f32 v[236:237], v230
    v_cvt_f64_f32 v[238:239], v231
    ds_add_f64 v36, v[232:233] offset:768
    ds_add_f64 v37, v[234:235] offset:768
    ds_add_f64 v38, v[236:237] offset:768
    ds_add_f64 v39, v[238:239] offset:768
    v_pk_mul_f32 v[220:221], v[220:221], v[216:217]
    v_pk_mul_f32 v[222:223], v[222:223], v[218:219]
    v_pk_fma_f32 v[72:73], v[72:73], v[42:43], v[72:73]
    v_pk_fma_f32 v[80:81], v[80:81], v[50:51], v[80:81]
    v_pk_add_f32 v[40:41], v[40:41], 1.0 op_sel_hi:[1,0]
    v_pk_add_f32 v[48:49], v[48:49], 1.0 op_sel_hi:[1,0]
    v_pk_fma_f32 v[72:73], v[74:75], v[40:41], v[72:73]
    v_pk_fma_f32 v[80:81], v[82:83], v[48:49], v[80:81]
    v_pk_fma_f32 v[40:41], v[40:41], v[42:43], v[40:41]
    v_pk_fma_f32 v[48:49], v[48:49], v[50:51], v[48:49]
    v_pk_fma_f32 v[72:73], v[72:73], v[44:45], v[72:73]
    v_pk_fma_f32 v[80:81], v[80:81], v[52:53], v[80:81]
    v_pk_fma_f32 v[72:73], v[76:77], v[40:41], v[72:73]
    v_pk_fma_f32 v[80:81], v[84:85], v[48:49], v[80:81]
    v_pk_fma_f32 v[40:41], v[40:41], v[44:45], v[40:41]
    v_pk_fma_f32 v[48:49], v[48:49], v[52:53], v[48:49]
    v_pk_fma_f32 v[72:73], v[72:73], v[46:47], v[72:73]
    v_pk_fma_f32 v[80:81], v[80:81], v[54:55], v[80:81]
    v_pk_fma_f32 v[228:229], v[78:79], v[40:41], v[72:73]
    v_pk_fma_f32 v[230:231], v[86:87], v[48:49], v[80:81]
    v_pk_fma_f32 v[224:225], v[40:41], v[46:47], v[40:41]
    v_pk_fma_f32 v[226:227], v[48:49], v[54:55], v[48:49]
    v_pk_fma_f32 v[28:29], v[224:225], v[226:227], v[28:29]
    v_mfma_f32_32x32x16_bf16 v[72:87], v[88:91], v[156:159], 0
    v_rcp_f32 v224, v224
    v_rcp_f32 v225, v225
    v_rcp_f32 v226, v226
    v_rcp_f32 v227, v227
    v_mfma_f32_32x32x16_bf16 v[72:87], v[92:95], v[172:175], v[72:87]
    v_exp_f32 v40, v56
    v_exp_f32 v41, v57
    v_exp_f32 v42, v58
    ds_read_b128 v[120:123], v11 offset:7168
    ds_read_b128 v[36:39], v4 offset:32
    v_mfma_f32_32x32x16_bf16 v[72:87], v[96:99], v[188:191], v[72:87]
    v_exp_f32 v43, v59
    v_exp_f32 v44, v60
    v_exp_f32 v45, v61
    v_mfma_f32_32x32x16_bf16 v[72:87], v[100:103], v[204:207], v[72:87]
    v_exp_f32 v46, v62
    v_exp_f32 v47, v63
    v_exp_f32 v48, v64
    v_mfma_f32_32x32x16_bf16 v[72:87], v[104:107], v[140:143], v[72:87]
    v_exp_f32 v49, v65
    v_exp_f32 v50, v66
    v_exp_f32 v51, v67
    v_mfma_f32_32x32x16_bf16 v[72:87], v[108:111], v[124:127], v[72:87]
    s_waitcnt vmcnt(1)
    ds_read_b128 v[88:91], v6
    ds_read_b128 v[92:95], v7
    ds_read_b128 v[96:99], v8
    ds_read_b128 v[100:103], v9
    ds_read_b128 v[108:111], v15 offset:1
    v_exp_f32 v52, v68
    v_exp_f32 v53, v69
    v_exp_f32 v54, v70
    v_exp_f32 v55, v71
    v_cvt_f64_f32 v[232:233], v220
    v_cvt_f64_f32 v[234:235], v221
    v_cvt_f64_f32 v[236:237], v222
    v_cvt_f64_f32 v[238:239], v223
    ds_add_f64 v32, v[232:233] offset:0
    ds_add_f64 v33, v[234:235] offset:0
    ds_add_f64 v34, v[236:237] offset:0
    ds_add_f64 v35, v[238:239] offset:0
    v_pk_mul_f32 v[228:229], v[228:229], v[224:225]
    v_pk_mul_f32 v[230:231], v[230:231], v[226:227]
    v_pk_fma_f32 v[56:57], v[56:57], v[42:43], v[56:57]
    v_pk_fma_f32 v[64:65], v[64:65], v[50:51], v[64:65]
    v_pk_add_f32 v[40:41], v[40:41], 1.0 op_sel_hi:[1,0]
    v_pk_add_f32 v[48:49], v[48:49], 1.0 op_sel_hi:[1,0]
    v_pk_fma_f32 v[56:57], v[58:59], v[40:41], v[56:57]
    v_pk_fma_f32 v[64:65], v[66:67], v[48:49], v[64:65]
    v_pk_fma_f32 v[40:41], v[40:41], v[42:43], v[40:41]
    v_pk_fma_f32 v[48:49], v[48:49], v[50:51], v[48:49]
    v_pk_fma_f32 v[56:57], v[56:57], v[44:45], v[56:57]
    v_pk_fma_f32 v[64:65], v[64:65], v[52:53], v[64:65]
    v_pk_fma_f32 v[56:57], v[60:61], v[40:41], v[56:57]
    v_pk_fma_f32 v[64:65], v[68:69], v[48:49], v[64:65]
    v_pk_fma_f32 v[40:41], v[40:41], v[44:45], v[40:41]
    v_pk_fma_f32 v[48:49], v[48:49], v[52:53], v[48:49]
    v_pk_fma_f32 v[56:57], v[56:57], v[46:47], v[56:57]
    v_pk_fma_f32 v[64:65], v[64:65], v[54:55], v[64:65]
    v_pk_fma_f32 v[220:221], v[62:63], v[40:41], v[56:57]
    v_pk_fma_f32 v[222:223], v[70:71], v[48:49], v[64:65]
    v_pk_fma_f32 v[216:217], v[40:41], v[46:47], v[40:41]
    v_pk_fma_f32 v[218:219], v[48:49], v[54:55], v[48:49]
    v_pk_fma_f32 v[28:29], v[216:217], v[218:219], v[28:29]
    s_waitcnt lgkmcnt(4)
    s_cmp_ge_u32 s37, 3
    s_cselect_b32 s6, 10000, 0
    s_cselect_b32 s10, 640000, 0
    v_mfma_f32_32x32x16_bf16 v[56:71], v[88:91], v[144:147], 0
    s_add_u32 m0, s36, 0
    s_nop 0
    buffer_load_dwordx4 v[16:17], s[4:7], 0 idxen offen lds
    v_rcp_f32 v216, v216
    v_rcp_f32 v217, v217
    v_rcp_f32 v218, v218
    v_rcp_f32 v219, v219
    v_mfma_f32_32x32x16_bf16 v[56:71], v[92:95], v[160:163], v[56:71]
    s_add_u32 m0, s36, 1024
    s_nop 0
    buffer_load_dwordx4 v[18:19], s[4:7], 0 idxen offen lds
    v_exp_f32 v40, v72
    v_exp_f32 v41, v73
    v_exp_f32 v42, v74
    ds_read_b128 v[124:127], v11 offset:10752
    v_mfma_f32_32x32x16_bf16 v[56:71], v[96:99], v[176:179], v[56:71]
    s_add_u32 m0, s36, 2048
    s_nop 0
    buffer_load_dwordx4 v[20:21], s[4:7], 0 idxen offen lds
    v_exp_f32 v43, v75
    v_exp_f32 v44, v76
    v_exp_f32 v45, v77
    v_cmp_ne_u32 vcc, v36, v39
    v_mfma_f32_32x32x16_bf16 v[56:71], v[100:103], v[192:195], v[56:71]
    s_add_u32 m0, s36, 3072
    s_nop 0
    buffer_load_dwordx4 v[22:23], s[4:7], 0 idxen offen lds
    v_exp_f32 v46, v78
    v_exp_f32 v47, v79
    v_exp_f32 v48, v80
    s_cmp_eq_u64 vcc, 0
    s_cselect_b32 s29, 1, 0
    s_waitcnt vmcnt(4)
    v_mfma_f32_32x32x16_bf16 v[56:71], v[248:251], v[128:131], v[56:71]
    buffer_load_dwordx4 v[104:107], v[24:25], s[8:11], 0 idxen offen
    v_exp_f32 v49, v81
    v_exp_f32 v50, v82
    v_exp_f32 v51, v83
    v_mfma_f32_32x32x16_bf16 v[56:71], v[108:111], v[112:115], v[56:71]
    v_exp_f32 v52, v84
    v_exp_f32 v53, v85
    v_exp_f32 v54, v86
    v_exp_f32 v55, v87
    v_cvt_f64_f32 v[232:233], v228
    v_cvt_f64_f32 v[234:235], v229
    v_cvt_f64_f32 v[236:237], v230
    v_cvt_f64_f32 v[238:239], v231
    ds_add_f64 v32, v[232:233] offset:256
    ds_add_f64 v33, v[234:235] offset:256
    ds_add_f64 v34, v[236:237] offset:256
    ds_add_f64 v35, v[238:239] offset:256
    v_pk_mul_f32 v[220:221], v[220:221], v[216:217]
    v_pk_mul_f32 v[222:223], v[222:223], v[218:219]
    v_pk_fma_f32 v[72:73], v[72:73], v[42:43], v[72:73]
    v_pk_fma_f32 v[80:81], v[80:81], v[50:51], v[80:81]
    v_pk_add_f32 v[40:41], v[40:41], 1.0 op_sel_hi:[1,0]
    v_pk_add_f32 v[48:49], v[48:49], 1.0 op_sel_hi:[1,0]
    v_pk_fma_f32 v[72:73], v[74:75], v[40:41], v[72:73]
    v_pk_fma_f32 v[80:81], v[82:83], v[48:49], v[80:81]
    v_pk_fma_f32 v[40:41], v[40:41], v[42:43], v[40:41]
    v_pk_fma_f32 v[48:49], v[48:49], v[50:51], v[48:49]
    v_pk_fma_f32 v[72:73], v[72:73], v[44:45], v[72:73]
    v_pk_fma_f32 v[80:81], v[80:81], v[52:53], v[80:81]
    v_pk_fma_f32 v[72:73], v[76:77], v[40:41], v[72:73]
    v_pk_fma_f32 v[80:81], v[84:85], v[48:49], v[80:81]
    v_pk_fma_f32 v[40:41], v[40:41], v[44:45], v[40:41]
    v_pk_fma_f32 v[48:49], v[48:49], v[52:53], v[48:49]
    v_pk_fma_f32 v[72:73], v[72:73], v[46:47], v[72:73]
    v_pk_fma_f32 v[80:81], v[80:81], v[54:55], v[80:81]
    v_pk_fma_f32 v[228:229], v[78:79], v[40:41], v[72:73]
    v_pk_fma_f32 v[230:231], v[86:87], v[48:49], v[80:81]
    v_pk_fma_f32 v[224:225], v[40:41], v[46:47], v[40:41]
    v_pk_fma_f32 v[226:227], v[48:49], v[54:55], v[48:49]
    v_pk_fma_f32 v[28:29], v[224:225], v[226:227], v[28:29]
    s_sub_u32 s37, s37, 1
    s_cmp_eq_u32 s37, 1
    s_cbranch_scc0 B_W2T000
    s_mov_b32 s16, s60
    s_and_b32 s17, s61, 0xffff
    s_mov_b32 s18, 16384
    s_mov_b32 s19, 0x20000
    v_lshlrev_b32 v247, 4, v211
    s_lshl_b32 s24, s32, 11
    s_add_u32 m0, s24, 140544
    s_add_u32 s25, s24, 0
    buffer_load_dwordx4 v247, s[16:19], s25 offen lds
    s_add_u32 m0, s24, 141568
    s_add_u32 s25, s24, 1024
    buffer_load_dwordx4 v247, s[16:19], s25 offen lds
    s_mov_b32 s16, s62
    s_and_b32 s17, s63, 0xffff
    s_mov_b32 s18, 128
    s_mov_b32 s19, 0x20000
    s_mov_b32 m0, 156928
    s_nop 0
    buffer_load_dwordx4 v247, s[16:19], 0 offen lds
B_W2T000:
    s_cmp_eq_u32 s37, 2
    s_cbranch_scc0 B_PT0002
    s_setprio 1
B_PT0002:
    s_cmp_eq_u32 s37, 1
    s_cbranch_scc0 B_PT0001
    s_setprio 0
B_PT0001:
    s_cmp_eq_u32 s37, 0
    s_cbranch_scc1 B_DRAIN00
    s_cmp_eq_u32 s29, 0
    s_cbranch_scc0 B_T101
B_T100:
    v_mfma_f32_32x32x16_bf16 v[72:87], v[88:91], v[148:151], 0
    v_rcp_f32 v224, v224
    v_rcp_f32 v225, v225
    v_rcp_f32 v226, v226
    v_rcp_f32 v227, v227
    v_mfma_f32_32x32x16_bf16 v[72:87], v[92:95], v[164:167], v[72:87]
    v_exp_f32 v40, v56
    v_exp_f32 v41, v57
    v_exp_f32 v42, v58
    ds_read_b32 v26, v5 offset:64
    ds_read_u16 v15, v3 offset:512
    v_mfma_f32_32x32x16_bf16 v[72:87], v[96:99], v[180:183], v[72:87]
    v_exp_f32 v43, v59
    v_exp_f32 v44, v60
    v_exp_f32 v45, v61
    v_add_u32 v36, v36, v14
    v_add_u32 v37, v37, v14
    v_add_u32 v38, v38, v14
    v_add_u32 v39, v39, v14
    v_mfma_f32_32x32x16_bf16 v[72:87], v[100:103], v[196:199], v[72:87]
    v_exp_f32 v46, v62
    v_exp_f32 v47, v63
    v_exp_f32 v48, v64
    v_mfma_f32_32x32x16_bf16 v[72:87], v[248:251], v[132:135], v[72:87]
    v_exp_f32 v49, v65
    v_exp_f32 v50, v66
    v_exp_f32 v51, v67
    v_mfma_f32_32x32x16_bf16 v[72:87], v[108:111], v[116:119], v[72:87]
    v_exp_f32 v52, v68
    v_exp_f32 v53, v69
    v_exp_f32 v54, v70
    v_exp_f32 v55, v71
    v_cvt_f64_f32 v[232:233], v220
    v_cvt_f64_f32 v[234:235], v221
    v_cvt_f64_f32 v[236:237], v222
    v_cvt_f64_f32 v[238:239], v223
    ds_add_f64 v32, v[232:233] offset:512
    ds_add_f64 v33, v[234:235] offset:512
    ds_add_f64 v34, v[236:237] offset:512
    ds_add_f64 v35, v[238:239] offset:512
    v_pk_mul_f32 v[228:229], v[228:229], v[224:225]
    v_pk_mul_f32 v[230:231], v[230:231], v[226:227]
    v_pk_fma_f32 v[56:57], v[56:57], v[42:43], v[56:57]
    v_pk_fma_f32 v[64:65], v[64:65], v[50:51], v[64:65]
    v_pk_add_f32 v[40:41], v[40:41], 1.0 op_sel_hi:[1,0]
    v_pk_add_f32 v[48:49], v[48:49], 1.0 op_sel_hi:[1,0]
    v_pk_fma_f32 v[56:57], v[58:59], v[40:41], v[56:57]
    v_pk_fma_f32 v[64:65], v[66:67], v[48:49], v[64:65]
    v_pk_fma_f32 v[40:41], v[40:41], v[42:43], v[40:41]
    v_pk_fma_f32 v[48:49], v[48:49], v[50:51], v[48:49]
    v_pk_fma_f32 v[56:57], v[56:57], v[44:45], v[56:57]
    v_pk_fma_f32 v[64:65], v[64:65], v[52:53], v[64:65]
    v_pk_fma_f32 v[56:57], v[60:61], v[40:41], v[56:57]
    v_pk_fma_f32 v[64:65], v[68:69], v[48:49], v[64:65]
    v_pk_fma_f32 v[40:41], v[40:41], v[44:45], v[40:41]
    v_pk_fma_f32 v[48:49], v[48:49], v[52:53], v[48:49]
    v_pk_fma_f32 v[56:57], v[56:57], v[46:47], v[56:57]
    v_pk_fma_f32 v[64:65], v[64:65], v[54:55], v[64:65]
    v_pk_fma_f32 v[220:221], v[62:63], v[40:41], v[56:57]
    v_pk_fma_f32 v[222:223], v[70:71], v[48:49], v[64:65]
    v_pk_fma_f32 v[216:217], v[40:41], v[46:47], v[40:41]
    v_pk_fma_f32 v[218:219], v[48:49], v[54:55], v[48:49]
    v_pk_fma_f32 v[28:29], v[216:217], v[218:219], v[28:29]
    s_waitcnt lgkmcnt(4)
    v_mfma_f32_32x32x16_bf16 v[56:71], v[88:91], v[152:155], 0
    v_rcp_f32 v216, v216
    v_rcp_f32 v217, v217
    v_rcp_f32 v218, v218
    v_rcp_f32 v219, v219
    v_mfma_f32_32x32x16_bf16 v[56:71], v[92:95], v[168:171], v[56:71]
    v_exp_f32 v40, v72
    v_exp_f32 v41, v73
    v_exp_f32 v42, v74
    v_add_u32 v27, v26, v13
    v_lshrrev_b32 v27, 14, v27
    v_lshl_add_u32 v11, v27, 5, v12
    v_add_u32 v15, v15, v241
    ds_read_b128 v[112:115], v11 offset:0
    ds_read_b128 v[116:119], v11 offset:3584
    v_mfma_f32_32x32x16_bf16 v[56:71], v[96:99], v[184:187], v[56:71]
    v_exp_f32 v43, v75
    v_exp_f32 v44, v76
    v_exp_f32 v45, v77
    ds_read_u16 v16, v1 offset:768
    ds_read_u16 v18, v1 offset:784
    ds_read_u16 v20, v1 offset:832
    ds_read_u16 v22, v1 offset:848
    ds_read_b32 v24, v2 offset:768
    v_mfma_f32_32x32x16_bf16 v[56:71], v[100:103], v[200:203], v[56:71]
    v_exp_f32 v46, v78
    v_exp_f32 v47, v79
    v_exp_f32 v48, v80
    v_mfma_f32_32x32x16_bf16 v[56:71], v[248:251], v[136:139], v[56:71]
    v_exp_f32 v49, v81
    v_exp_f32 v50, v82
    v_exp_f32 v51, v83
    v_mfma_f32_32x32x16_bf16 v[56:71], v[108:111], v[120:123], v[56:71]
    v_exp_f32 v52, v84
    v_exp_f32 v53, v85
    v_exp_f32 v54, v86
    v_exp_f32 v55, v87
    v_cvt_f64_f32 v[232:233], v228
    v_cvt_f64_f32 v[234:235], v229
    v_cvt_f64_f32 v[236:237], v230
    v_cvt_f64_f32 v[238:239], v231
    ds_add_f64 v32, v[232:233] offset:768
    ds_add_f64 v33, v[234:235] offset:768
    ds_add_f64 v34, v[236:237] offset:768
    ds_add_f64 v35, v[238:239] offset:768
    v_pk_mul_f32 v[220:221], v[220:221], v[216:217]
    v_pk_mul_f32 v[222:223], v[222:223], v[218:219]
    v_pk_fma_f32 v[72:73], v[72:73], v[42:43], v[72:73]
    v_pk_fma_f32 v[80:81], v[80:81], v[50:51], v[80:81]
    v_pk_add_f32 v[40:41], v[40:41], 1.0 op_sel_hi:[1,0]
    v_pk_add_f32 v[48:49], v[48:49], 1.0 op_sel_hi:[1,0]
    v_pk_fma_f32 v[72:73], v[74:75], v[40:41], v[72:73]
    v_pk_fma_f32 v[80:81], v[82:83], v[48:49], v[80:81]
    v_pk_fma_f32 v[40:41], v[40:41], v[42:43], v[40:41]
    v_pk_fma_f32 v[48:49], v[48:49], v[50:51], v[48:49]
    v_pk_fma_f32 v[72:73], v[72:73], v[44:45], v[72:73]
    v_pk_fma_f32 v[80:81], v[80:81], v[52:53], v[80:81]
    v_pk_fma_f32 v[72:73], v[76:77], v[40:41], v[72:73]
    v_pk_fma_f32 v[80:81], v[84:85], v[48:49], v[80:81]
    v_pk_fma_f32 v[40:41], v[40:41], v[44:45], v[40:41]
    v_pk_fma_f32 v[48:49], v[48:49], v[52:53], v[48:49]
    v_pk_fma_f32 v[72:73], v[72:73], v[46:47], v[72:73]
    v_pk_fma_f32 v[80:81], v[80:81], v[54:55], v[80:81]
    v_pk_fma_f32 v[228:229], v[78:79], v[40:41], v[72:73]
    v_pk_fma_f32 v[230:231], v[86:87], v[48:49], v[80:81]
    v_pk_fma_f32 v[224:225], v[40:41], v[46:47], v[40:41]
    v_pk_fma_f32 v[226:227], v[48:49], v[54:55], v[48:49]
    v_pk_fma_f32 v[28:29], v[224:225], v[226:227], v[28:29]
    v_mfma_f32_32x32x16_bf16 v[72:87], v[88:91], v[156:159], 0
    v_rcp_f32 v224, v224
    v_rcp_f32 v225, v225
    v_rcp_f32 v226, v226
    v_rcp_f32 v227, v227
    v_mfma_f32_32x32x16_bf16 v[72:87], v[92:95], v[172:175], v[72:87]
    v_exp_f32 v40, v56
    v_exp_f32 v41, v57
    v_exp_f32 v42, v58
    ds_read_b128 v[120:123], v11 offset:7168
    ds_read_b128 v[32:35], v4 offset:64
    v_mfma_f32_32x32x16_bf16 v[72:87], v[96:99], v[188:191], v[72:87]
    v_exp_f32 v43, v59
    v_exp_f32 v44, v60
    v_exp_f32 v45, v61
    v_mfma_f32_32x32x16_bf16 v[72:87], v[100:103], v[204:207], v[72:87]
    v_exp_f32 v46, v62
    v_exp_f32 v47, v63
    v_exp_f32 v48, v64
    v_mfma_f32_32x32x16_bf16 v[72:87], v[248:251], v[140:143], v[72:87]
    v_exp_f32 v49, v65
    v_exp_f32 v50, v66
    v_exp_f32 v51, v67
    v_mfma_f32_32x32x16_bf16 v[72:87], v[108:111], v[124:127], v[72:87]
    s_waitcnt vmcnt(1)
    ds_read_b128 v[88:91], v6
    ds_read_b128 v[92:95], v7
    ds_read_b128 v[96:99], v8
    ds_read_b128 v[100:103], v9
    ds_read_b128 v[108:111], v15 offset:1
    v_exp_f32 v52, v68
    v_exp_f32 v53, v69
    v_exp_f32 v54, v70
    v_exp_f32 v55, v71
    v_cvt_f64_f32 v[232:233], v220
    v_cvt_f64_f32 v[234:235], v221
    v_cvt_f64_f32 v[236:237], v222
    v_cvt_f64_f32 v[238:239], v223
    ds_add_f64 v36, v[232:233] offset:0
    ds_add_f64 v37, v[234:235] offset:0
    ds_add_f64 v38, v[236:237] offset:0
    ds_add_f64 v39, v[238:239] offset:0
    v_pk_mul_f32 v[228:229], v[228:229], v[224:225]
    v_pk_mul_f32 v[230:231], v[230:231], v[226:227]
    v_pk_fma_f32 v[56:57], v[56:57], v[42:43], v[56:57]
    v_pk_fma_f32 v[64:65], v[64:65], v[50:51], v[64:65]
    v_pk_add_f32 v[40:41], v[40:41], 1.0 op_sel_hi:[1,0]
    v_pk_add_f32 v[48:49], v[48:49], 1.0 op_sel_hi:[1,0]
    v_pk_fma_f32 v[56:57], v[58:59], v[40:41], v[56:57]
    v_pk_fma_f32 v[64:65], v[66:67], v[48:49], v[64:65]
    v_pk_fma_f32 v[40:41], v[40:41], v[42:43], v[40:41]
    v_pk_fma_f32 v[48:49], v[48:49], v[50:51], v[48:49]
    v_pk_fma_f32 v[56:57], v[56:57], v[44:45], v[56:57]
    v_pk_fma_f32 v[64:65], v[64:65], v[52:53], v[64:65]
    v_pk_fma_f32 v[56:57], v[60:61], v[40:41], v[56:57]
    v_pk_fma_f32 v[64:65], v[68:69], v[48:49], v[64:65]
    v_pk_fma_f32 v[40:41], v[40:41], v[44:45], v[40:41]
    v_pk_fma_f32 v[48:49], v[48:49], v[52:53], v[48:49]
    v_pk_fma_f32 v[56:57], v[56:57], v[46:47], v[56:57]
    v_pk_fma_f32 v[64:65], v[64:65], v[54:55], v[64:65]
    v_pk_fma_f32 v[220:221], v[62:63], v[40:41], v[56:57]
    v_pk_fma_f32 v[222:223], v[70:71], v[48:49], v[64:65]
    v_pk_fma_f32 v[216:217], v[40:41], v[46:47], v[40:41]
    v_pk_fma_f32 v[218:219], v[48:49], v[54:55], v[48:49]
    v_pk_fma_f32 v[28:29], v[216:217], v[218:219], v[28:29]
    s_waitcnt lgkmcnt(4)
    s_cmp_ge_u32 s37, 3
    s_cselect_b32 s6, 10000, 0
    s_cselect_b32 s10, 640000, 0
    v_mfma_f32_32x32x16_bf16 v[56:71], v[88:91], v[144:147], 0
    s_add_u32 m0, s36, 0
    s_nop 0
    buffer_load_dwordx4 v[16:17], s[4:7], 0 idxen offen lds
    v_rcp_f32 v216, v216
    v_rcp_f32 v217, v217
    v_rcp_f32 v218, v218
    v_rcp_f32 v219, v219
    v_mfma_f32_32x32x16_bf16 v[56:71], v[92:95], v[160:163], v[56:71]
    s_add_u32 m0, s36, 1024
    s_nop 0
    buffer_load_dwordx4 v[18:19], s[4:7], 0 idxen offen lds
    v_exp_f32 v40, v72
    v_exp_f32 v41, v73
    v_exp_f32 v42, v74
    ds_read_b128 v[124:127], v11 offset:10752
    v_mfma_f32_32x32x16_bf16 v[56:71], v[96:99], v[176:179], v[56:71]
    s_add_u32 m0, s36, 2048
    s_nop 0
    buffer_load_dwordx4 v[20:21], s[4:7], 0 idxen offen lds
    v_exp_f32 v43, v75
    v_exp_f32 v44, v76
    v_exp_f32 v45, v77
    v_cmp_ne_u32 vcc, v32, v35
    v_mfma_f32_32x32x16_bf16 v[56:71], v[100:103], v[192:195], v[56:71]
    s_add_u32 m0, s36, 3072
    s_nop 0
    buffer_load_dwordx4 v[22:23], s[4:7], 0 idxen offen lds
    v_exp_f32 v46, v78
    v_exp_f32 v47, v79
    v_exp_f32 v48, v80
    s_cmp_eq_u64 vcc, 0
    s_cselect_b32 s29, 1, 0
    s_waitcnt vmcnt(4)
    v_mfma_f32_32x32x16_bf16 v[56:71], v[104:107], v[128:131], v[56:71]
    buffer_load_dwordx4 v[248:251], v[24:25], s[8:11], 0 idxen offen
    v_exp_f32 v49, v81
    v_exp_f32 v50, v82
    v_exp_f32 v51, v83
    v_mfma_f32_32x32x16_bf16 v[56:71], v[108:111], v[112:115], v[56:71]
    v_exp_f32 v52, v84
    v_exp_f32 v53, v85
    v_exp_f32 v54, v86
    v_exp_f32 v55, v87
    v_cvt_f64_f32 v[232:233], v228
    v_cvt_f64_f32 v[234:235], v229
    v_cvt_f64_f32 v[236:237], v230
    v_cvt_f64_f32 v[238:239], v231
    ds_add_f64 v36, v[232:233] offset:256
    ds_add_f64 v37, v[234:235] offset:256
    ds_add_f64 v38, v[236:237] offset:256
    ds_add_f64 v39, v[238:239] offset:256
    v_pk_mul_f32 v[220:221], v[220:221], v[216:217]
    v_pk_mul_f32 v[222:223], v[222:223], v[218:219]
    v_pk_fma_f32 v[72:73], v[72:73], v[42:43], v[72:73]
    v_pk_fma_f32 v[80:81], v[80:81], v[50:51], v[80:81]
    v_pk_add_f32 v[40:41], v[40:41], 1.0 op_sel_hi:[1,0]
    v_pk_add_f32 v[48:49], v[48:49], 1.0 op_sel_hi:[1,0]
    v_pk_fma_f32 v[72:73], v[74:75], v[40:41], v[72:73]
    v_pk_fma_f32 v[80:81], v[82:83], v[48:49], v[80:81]
    v_pk_fma_f32 v[40:41], v[40:41], v[42:43], v[40:41]
    v_pk_fma_f32 v[48:49], v[48:49], v[50:51], v[48:49]
    v_pk_fma_f32 v[72:73], v[72:73], v[44:45], v[72:73]
    v_pk_fma_f32 v[80:81], v[80:81], v[52:53], v[80:81]
    v_pk_fma_f32 v[72:73], v[76:77], v[40:41], v[72:73]
    v_pk_fma_f32 v[80:81], v[84:85], v[48:49], v[80:81]
    v_pk_fma_f32 v[40:41], v[40:41], v[44:45], v[40:41]
    v_pk_fma_f32 v[48:49], v[48:49], v[52:53], v[48:49]
    v_pk_fma_f32 v[72:73], v[72:73], v[46:47], v[72:73]
    v_pk_fma_f32 v[80:81], v[80:81], v[54:55], v[80:81]
    v_pk_fma_f32 v[228:229], v[78:79], v[40:41], v[72:73]
    v_pk_fma_f32 v[230:231], v[86:87], v[48:49], v[80:81]
    v_pk_fma_f32 v[224:225], v[40:41], v[46:47], v[40:41]
    v_pk_fma_f32 v[226:227], v[48:49], v[54:55], v[48:49]
    v_pk_fma_f32 v[28:29], v[224:225], v[226:227], v[28:29]
    v_add_u32 v1, 512, v1
    v_add_u32 v2, 512, v2
    v_add_u32 v3, 512, v3
    v_add_u32 v4, 64, v4
    v_add_u32 v5, 64, v5
    s_sub_u32 s37, s37, 1
    s_cmp_eq_u32 s37, 1
    s_cbranch_scc0 B_W2T100
    s_mov_b32 s16, s60
    s_and_b32 s17, s61, 0xffff
    s_mov_b32 s18, 16384
    s_mov_b32 s19, 0x20000
    v_lshlrev_b32 v247, 4, v211
    s_lshl_b32 s24, s32, 11
    s_add_u32 m0, s24, 140544
    s_add_u32 s25, s24, 0
    buffer_load_dwordx4 v247, s[16:19], s25 offen lds
    s_add_u32 m0, s24, 141568
    s_add_u32 s25, s24, 1024
    buffer_load_dwordx4 v247, s[16:19], s25 offen lds
    s_mov_b32 s16, s62
    s_and_b32 s17, s63, 0xffff
    s_mov_b32 s18, 128
    s_mov_b32 s19, 0x20000
    s_mov_b32 m0, 156928
    s_nop 0
    buffer_load_dwordx4 v247, s[16:19], 0 offen lds
B_W2T100:
    s_cmp_eq_u32 s37, 2
    s_cbranch_scc0 B_PT1002
    s_setprio 1
B_PT1002:
    s_cmp_eq_u32 s37, 1
    s_cbranch_scc0 B_PT1001
    s_setprio 0
B_PT1001:
    s_cmp_eq_u32 s37, 0
    s_cbranch_scc1 B_DRAIN10
    s_cmp_eq_u32 s29, 0
    s_cbranch_scc0 B_T001
    s_branch B_T000
B_T101:
    v_mfma_f32_32x32x16_bf16 v[72:87], v[88:91], v[148:151], 0
    v_rcp_f32 v224, v224
    v_rcp_f32 v225, v225
    v_rcp_f32 v226, v226
    v_rcp_f32 v227, v227
    v_mfma_f32_32x32x16_bf16 v[72:87], v[92:95], v[164:167], v[72:87]
    v_exp_f32 v40, v56
    v_exp_f32 v41, v57
    v_exp_f32 v42, v58
    ds_read_b32 v26, v5 offset:64
    ds_read_u16 v15, v3 offset:512
    v_mfma_f32_32x32x16_bf16 v[72:87], v[96:99], v[180:183], v[72:87]
    v_exp_f32 v43, v59
    v_exp_f32 v44, v60
    v_exp_f32 v45, v61
    v_add_u32 v36, v36, v14
    v_mfma_f32_32x32x16_bf16 v[72:87], v[100:103], v[196:199], v[72:87]
    v_exp_f32 v46, v62
    v_exp_f32 v47, v63
    v_exp_f32 v48, v64
    v_mfma_f32_32x32x16_bf16 v[72:87], v[248:251], v[132:135], v[72:87]
    v_exp_f32 v49, v65
    v_exp_f32 v50, v66
    v_exp_f32 v51, v67
    v_mfma_f32_32x32x16_bf16 v[72:87], v[108:111], v[116:119], v[72:87]
    v_exp_f32 v52, v68
    v_exp_f32 v53, v69
    v_exp_f32 v54, v70
    v_exp_f32 v55, v71
    v_cvt_f64_f32 v[232:233], v220
    v_cvt_f64_f32 v[234:235], v221
    v_cvt_f64_f32 v[236:237], v222
    v_cvt_f64_f32 v[238:239], v223
    ds_add_f64 v32, v[232:233] offset:512
    ds_add_f64 v33, v[234:235] offset:512
    ds_add_f64 v34, v[236:237] offset:512
    ds_add_f64 v35, v[238:239] offset:512
    v_pk_mul_f32 v[228:229], v[228:229], v[224:225]
    v_pk_mul_f32 v[230:231], v[230:231], v[226:227]
    v_pk_fma_f32 v[56:57], v[56:57], v[42:43], v[56:57]
    v_pk_fma_f32 v[64:65], v[64:65], v[50:51], v[64:65]
    v_pk_add_f32 v[40:41], v[40:41], 1.0 op_sel_hi:[1,0]
    v_pk_add_f32 v[48:49], v[48:49], 1.0 op_sel_hi:[1,0]
    v_pk_fma_f32 v[56:57], v[58:59], v[40:41], v[56:57]
    v_pk_fma_f32 v[64:65], v[66:67], v[48:49], v[64:65]
    v_pk_fma_f32 v[40:41], v[40:41], v[42:43], v[40:41]
    v_pk_fma_f32 v[48:49], v[48:49], v[50:51], v[48:49]
    v_pk_fma_f32 v[56:57], v[56:57], v[44:45], v[56:57]
    v_pk_fma_f32 v[64:65], v[64:65], v[52:53], v[64:65]
    v_pk_fma_f32 v[56:57], v[60:61], v[40:41], v[56:57]
    v_pk_fma_f32 v[64:65], v[68:69], v[48:49], v[64:65]
    v_pk_fma_f32 v[40:41], v[40:41], v[44:45], v[40:41]
    v_pk_fma_f32 v[48:49], v[48:49], v[52:53], v[48:49]
    v_pk_fma_f32 v[56:57], v[56:57], v[46:47], v[56:57]
    v_pk_fma_f32 v[64:65], v[64:65], v[54:55], v[64:65]
    v_pk_fma_f32 v[220:221], v[62:63], v[40:41], v[56:57]
    v_pk_fma_f32 v[222:223], v[70:71], v[48:49], v[64:65]
    v_pk_fma_f32 v[216:217], v[40:41], v[46:47], v[40:41]
    v_pk_fma_f32 v[218:219], v[48:49], v[54:55], v[48:49]
    v_pk_mul_f32 v[236:237], v[220:221], v[218:219]
    v_pk_fma_f32 v[220:221], v[222:223], v[216:217], v[236:237]
    v_pk_mul_f32 v[216:217], v[216:217], v[218:219]
    s_waitcnt lgkmcnt(4)
    v_mfma_f32_32x32x16_bf16 v[56:71], v[88:91], v[152:155], 0
    v_mul_f32 v218, v216, v217
    v_mul_f32 v222, v220, v217
    v_fma_f32 v222, v221, v216, v222
    v_rcp_f32 v219, v218
    v_add_f32 v28, v28, v218
    v_mul_f32 v222, v222, v219
    v_cvt_f64_f32 v[232:233], v222
    ds_add_f64 v36, v[232:233] offset:0
    v_mfma_f32_32x32x16_bf16 v[56:71], v[92:95], v[168:171], v[56:71]
    v_exp_f32 v40, v72
    v_exp_f32 v41, v73
    v_exp_f32 v42, v74
    v_add_u32 v27, v26, v13
    v_lshrrev_b32 v27, 14, v27
    v_lshl_add_u32 v11, v27, 5, v12
    v_add_u32 v15, v15, v241
    ds_read_b128 v[112:115], v11 offset:0
    ds_read_b128 v[116:119], v11 offset:3584
    v_mfma_f32_32x32x16_bf16 v[56:71], v[96:99], v[184:187], v[56:71]
    v_exp_f32 v43, v75
    v_exp_f32 v44, v76
    v_exp_f32 v45, v77
    ds_read_u16 v16, v1 offset:768
    ds_read_u16 v18, v1 offset:784
    ds_read_u16 v20, v1 offset:832
    ds_read_u16 v22, v1 offset:848
    ds_read_b32 v24, v2 offset:768
    v_mfma_f32_32x32x16_bf16 v[56:71], v[100:103], v[200:203], v[56:71]
    v_exp_f32 v46, v78
    v_exp_f32 v47, v79
    v_exp_f32 v48, v80
    v_mfma_f32_32x32x16_bf16 v[56:71], v[248:251], v[136:139], v[56:71]
    v_exp_f32 v49, v81
    v_exp_f32 v50, v82
    v_exp_f32 v51, v83
    v_mfma_f32_32x32x16_bf16 v[56:71], v[108:111], v[120:123], v[56:71]
    v_exp_f32 v52, v84
    v_exp_f32 v53, v85
    v_exp_f32 v54, v86
    v_exp_f32 v55, v87
    v_cvt_f64_f32 v[232:233], v228
    v_cvt_f64_f32 v[234:235], v229
    v_cvt_f64_f32 v[236:237], v230
    v_cvt_f64_f32 v[238:239], v231
    ds_add_f64 v32, v[232:233] offset:768
    ds_add_f64 v33, v[234:235] offset:768
    ds_add_f64 v34, v[236:237] offset:768
    ds_add_f64 v35, v[238:239] offset:768
    v_pk_fma_f32 v[72:73], v[72:73], v[42:43], v[72:73]
    v_pk_fma_f32 v[80:81], v[80:81], v[50:51], v[80:81]
    v_pk_add_f32 v[40:41], v[40:41], 1.0 op_sel_hi:[1,0]
    v_pk_add_f32 v[48:49], v[48:49], 1.0 op_sel_hi:[1,0]
    v_pk_fma_f32 v[72:73], v[74:75], v[40:41], v[72:73]
    v_pk_fma_f32 v[80:81], v[82:83], v[48:49], v[80:81]
    v_pk_fma_f32 v[40:41], v[40:41], v[42:43], v[40:41]
    v_pk_fma_f32 v[48:49], v[48:49], v[50:51], v[48:49]
    v_pk_fma_f32 v[72:73], v[72:73], v[44:45], v[72:73]
    v_pk_fma_f32 v[80:81], v[80:81], v[52:53], v[80:81]
    v_pk_fma_f32 v[72:73], v[76:77], v[40:41], v[72:73]
    v_pk_fma_f32 v[80:81], v[84:85], v[48:49], v[80:81]
    v_pk_fma_f32 v[40:41], v[40:41], v[44:45], v[40:41]
    v_pk_fma_f32 v[48:49], v[48:49], v[52:53], v[48:49]
    v_pk_fma_f32 v[72:73], v[72:73], v[46:47], v[72:73]
    v_pk_fma_f32 v[80:81], v[80:81], v[54:55], v[80:81]
    v_pk_fma_f32 v[228:229], v[78:79], v[40:41], v[72:73]
    v_pk_fma_f32 v[230:231], v[86:87], v[48:49], v[80:81]
    v_pk_fma_f32 v[224:225], v[40:41], v[46:47], v[40:41]
    v_pk_fma_f32 v[226:227], v[48:49], v[54:55], v[48:49]
    v_pk_mul_f32 v[236:237], v[228:229], v[226:227]
    v_pk_fma_f32 v[228:229], v[230:231], v[224:225], v[236:237]
    v_pk_mul_f32 v[224:225], v[224:225], v[226:227]
    v_mfma_f32_32x32x16_bf16 v[72:87], v[88:91], v[156:159], 0
    v_mul_f32 v226, v224, v225
    v_mul_f32 v230, v228, v225
    v_fma_f32 v230, v229, v224, v230
    v_rcp_f32 v227, v226
    v_add_f32 v28, v28, v226
    v_mul_f32 v230, v230, v227
    v_cvt_f64_f32 v[232:233], v230
    ds_add_f64 v36, v[232:233] offset:256
    v_mfma_f32_32x32x16_bf16 v[72:87], v[92:95], v[172:175], v[72:87]
    v_exp_f32 v40, v56
    v_exp_f32 v41, v57
    v_exp_f32 v42, v58
    ds_read_b128 v[120:123], v11 offset:7168
    ds_read_b128 v[32:35], v4 offset:64
    v_mfma_f32_32x32x16_bf16 v[72:87], v[96:99], v[188:191], v[72:87]
    v_exp_f32 v43, v59
    v_exp_f32 v44, v60
    v_exp_f32 v45, v61
    v_mfma_f32_32x32x16_bf16 v[72:87], v[100:103], v[204:207], v[72:87]
    v_exp_f32 v46, v62
    v_exp_f32 v47, v63
    v_exp_f32 v48, v64
    v_mfma_f32_32x32x16_bf16 v[72:87], v[248:251], v[140:143], v[72:87]
    v_exp_f32 v49, v65
    v_exp_f32 v50, v66
    v_exp_f32 v51, v67
    v_mfma_f32_32x32x16_bf16 v[72:87], v[108:111], v[124:127], v[72:87]
    s_waitcnt vmcnt(1)
    ds_read_b128 v[88:91], v6
    ds_read_b128 v[92:95], v7
    ds_read_b128 v[96:99], v8
    ds_read_b128 v[100:103], v9
    ds_read_b128 v[108:111], v15 offset:1
    v_exp_f32 v52, v68
    v_exp_f32 v53, v69
    v_exp_f32 v54, v70
    v_exp_f32 v55, v71
    v_pk_fma_f32 v[56:57], v[56:57], v[42:43], v[56:57]
    v_pk_fma_f32 v[64:65], v[64:65], v[50:51], v[64:65]
    v_pk_add_f32 v[40:41], v[40:41], 1.0 op_sel_hi:[1,0]
    v_pk_add_f32 v[48:49], v[48:49], 1.0 op_sel_hi:[1,0]
    v_pk_fma_f32 v[56:57], v[58:59], v[40:41], v[56:57]
    v_pk_fma_f32 v[64:65], v[66:67], v[48:49], v[64:65]
    v_pk_fma_f32 v[40:41], v[40:41], v[42:43], v[40:41]
    v_pk_fma_f32 v[48:49], v[48:49], v[50:51], v[48:49]
    v_pk_fma_f32 v[56:57], v[56:57], v[44:45], v[56:57]
    v_pk_fma_f32 v[64:65], v[64:65], v[52:53], v[64:65]
    v_pk_fma_f32 v[56:57], v[60:61], v[40:41], v[56:57]
    v_pk_fma_f32 v[64:65], v[68:69], v[48:49], v[64:65]
    v_pk_fma_f32 v[40:41], v[40:41], v[44:45], v[40:41]
    v_pk_fma_f32 v[48:49], v[48:49], v[52:53], v[48:49]
    v_pk_fma_f32 v[56:57], v[56:57], v[46:47], v[56:57]
    v_pk_fma_f32 v[64:65], v[64:65], v[54:55], v[64:65]
    v_pk_fma_f32 v[220:221], v[62:63], v[40:41], v[56:57]
    v_pk_fma_f32 v[222:223], v[70:71], v[48:49], v[64:65]
    v_pk_fma_f32 v[216:217], v[40:41], v[46:47], v[40:41]
    v_pk_fma_f32 v[218:219], v[48:49], v[54:55], v[48:49]
    v_pk_mul_f32 v[236:237], v[220:221], v[218:219]
    v_pk_fma_f32 v[220:221], v[222:223], v[216:217], v[236:237]
    v_pk_mul_f32 v[216:217], v[216:217], v[218:219]
    s_waitcnt lgkmcnt(0)
    s_cmp_ge_u32 s37, 3
    s_cselect_b32 s6, 10000, 0
    s_cselect_b32 s10, 640000, 0
    v_mfma_f32_32x32x16_bf16 v[56:71], v[88:91], v[144:147], 0
    s_add_u32 m0, s36, 0
    s_nop 0
    buffer_load_dwordx4 v[16:17], s[4:7], 0 idxen offen lds
    v_mul_f32 v218, v216, v217
    v_mul_f32 v222, v220, v217
    v_fma_f32 v222, v221, v216, v222
    v_rcp_f32 v219, v218
    v_add_f32 v28, v28, v218
    v_mul_f32 v222, v222, v219
    v_cvt_f64_f32 v[232:233], v222
    ds_add_f64 v36, v[232:233] offset:512
    v_mfma_f32_32x32x16_bf16 v[56:71], v[92:95], v[160:163], v[56:71]
    s_add_u32 m0, s36, 1024
    s_nop 0
    buffer_load_dwordx4 v[18:19], s[4:7], 0 idxen offen lds
    v_exp_f32 v40, v72
    v_exp_f32 v41, v73
    v_exp_f32 v42, v74
    ds_read_b128 v[124:127], v11 offset:10752
    v_mfma_f32_32x32x16_bf16 v[56:71], v[96:99], v[176:179], v[56:71]
    s_add_u32 m0, s36, 2048
    s_nop 0
    buffer_load_dwordx4 v[20:21], s[4:7], 0 idxen offen lds
    v_exp_f32 v43, v75
    v_exp_f32 v44, v76
    v_exp_f32 v45, v77
    v_cmp_ne_u32 vcc, v32, v35
    v_mfma_f32_32x32x16_bf16 v[56:71], v[100:103], v[192:195], v[56:71]
    s_add_u32 m0, s36, 3072
    s_nop 0
    buffer_load_dwordx4 v[22:23], s[4:7], 0 idxen offen lds
    v_exp_f32 v46, v78
    v_exp_f32 v47, v79
    v_exp_f32 v48, v80
    s_cmp_eq_u64 vcc, 0
    s_cselect_b32 s29, 1, 0
    s_waitcnt vmcnt(4)
    v_mfma_f32_32x32x16_bf16 v[56:71], v[104:107], v[128:131], v[56:71]
    buffer_load_dwordx4 v[248:251], v[24:25], s[8:11], 0 idxen offen
    v_exp_f32 v49, v81
    v_exp_f32 v50, v82
    v_exp_f32 v51, v83
    v_mfma_f32_32x32x16_bf16 v[56:71], v[108:111], v[112:115], v[56:71]
    v_exp_f32 v52, v84
    v_exp_f32 v53, v85
    v_exp_f32 v54, v86
    v_exp_f32 v55, v87
    v_pk_fma_f32 v[72:73], v[72:73], v[42:43], v[72:73]
    v_pk_fma_f32 v[80:81], v[80:81], v[50:51], v[80:81]
    v_pk_add_f32 v[40:41], v[40:41], 1.0 op_sel_hi:[1,0]
    v_pk_add_f32 v[48:49], v[48:49], 1.0 op_sel_hi:[1,0]
    v_pk_fma_f32 v[72:73], v[74:75], v[40:41], v[72:73]
    v_pk_fma_f32 v[80:81], v[82:83], v[48:49], v[80:81]
    v_pk_fma_f32 v[40:41], v[40:41], v[42:43], v[40:41]
    v_pk_fma_f32 v[48:49], v[48:49], v[50:51], v[48:49]
    v_pk_fma_f32 v[72:73], v[72:73], v[44:45], v[72:73]
    v_pk_fma_f32 v[80:81], v[80:81], v[52:53], v[80:81]
    v_pk_fma_f32 v[72:73], v[76:77], v[40:41], v[72:73]
    v_pk_fma_f32 v[80:81], v[84:85], v[48:49], v[80:81]
    v_pk_fma_f32 v[40:41], v[40:41], v[44:45], v[40:41]
    v_pk_fma_f32 v[48:49], v[48:49], v[52:53], v[48:49]
    v_pk_fma_f32 v[72:73], v[72:73], v[46:47], v[72:73]
    v_pk_fma_f32 v[80:81], v[80:81], v[54:55], v[80:81]
    v_pk_fma_f32 v[228:229], v[78:79], v[40:41], v[72:73]
    v_pk_fma_f32 v[230:231], v[86:87], v[48:49], v[80:81]
    v_pk_fma_f32 v[224:225], v[40:41], v[46:47], v[40:41]
    v_pk_fma_f32 v[226:227], v[48:49], v[54:55], v[48:49]
    v_pk_mul_f32 v[236:237], v[228:229], v[226:227]
    v_pk_fma_f32 v[228:229], v[230:231], v[224:225], v[236:237]
    v_pk_mul_f32 v[224:225], v[224:225], v[226:227]
    v_add_u32 v1, 512, v1
    v_add_u32 v2, 512, v2
    v_add_u32 v3, 512, v3
    v_add_u32 v4, 64, v4
    v_add_u32 v5, 64, v5
    s_sub_u32 s37, s37, 1
    s_cmp_eq_u32 s37, 1
    s_cbranch_scc0 B_W2T101
    s_mov_b32 s16, s60
    s_and_b32 s17, s61, 0xffff
    s_mov_b32 s18, 16384
    s_mov_b32 s19, 0x20000
    v_lshlrev_b32 v247, 4, v211
    s_lshl_b32 s24, s32, 11
    s_add_u32 m0, s24, 140544
    s_add_u32 s25, s24, 0
    buffer_load_dwordx4 v247, s[16:19], s25 offen lds
    s_add_u32 m0, s24, 141568
    s_add_u32 s25, s24, 1024
    buffer_load_dwordx4 v247, s[16:19], s25 offen lds
    s_mov_b32 s16, s62
    s_and_b32 s17, s63, 0xffff
    s_mov_b32 s18, 128
    s_mov_b32 s19, 0x20000
    s_mov_b32 m0, 156928
    s_nop 0
    buffer_load_dwordx4 v247, s[16:19], 0 offen lds
B_W2T101:
    s_cmp_eq_u32 s37, 2
    s_cbranch_scc0 B_PT1012
    s_setprio 1
B_PT1012:
    s_cmp_eq_u32 s37, 1
    s_cbranch_scc0 B_PT1011
    s_setprio 0
B_PT1011:
    s_cmp_eq_u32 s37, 0
    s_cbranch_scc1 B_DRAIN11
    s_cmp_eq_u32 s29, 0
    s_cbranch_scc0 B_T011
B_T010:
    v_mfma_f32_32x32x16_bf16 v[72:87], v[88:91], v[148:151], 0
    v_mul_f32 v226, v224, v225
    v_mul_f32 v230, v228, v225
    v_fma_f32 v230, v229, v224, v230
    v_rcp_f32 v227, v226
    v_add_f32 v28, v28, v226
    v_mul_f32 v230, v230, v227
    v_cvt_f64_f32 v[232:233], v230
    ds_add_f64 v36, v[232:233] offset:768
    v_mfma_f32_32x32x16_bf16 v[72:87], v[92:95], v[164:167], v[72:87]
    v_exp_f32 v40, v56
    v_exp_f32 v41, v57
    v_exp_f32 v42, v58
    ds_read_b32 v26, v5 offset:32
    ds_read_u16 v15, v3 offset:256
    v_mfma_f32_32x32x16_bf16 v[72:87], v[96:99], v[180:183], v[72:87]
    v_exp_f32 v43, v59
    v_exp_f32 v44, v60
    v_exp_f32 v45, v61
    v_add_u32 v32, v32, v14
    v_add_u32 v33, v33, v14
    v_add_u32 v34, v34, v14
    v_add_u32 v35, v35, v14
    v_mfma_f32_32x32x16_bf16 v[72:87], v[100:103], v[196:199], v[72:87]
    v_exp_f32 v46, v62
    v_exp_f32 v47, v63
    v_exp_f32 v48, v64
    v_mfma_f32_32x32x16_bf16 v[72:87], v[104:107], v[132:135], v[72:87]
    v_exp_f32 v49, v65
    v_exp_f32 v50, v66
    v_exp_f32 v51, v67
    v_mfma_f32_32x32x16_bf16 v[72:87], v[108:111], v[116:119], v[72:87]
    v_exp_f32 v52, v68
    v_exp_f32 v53, v69
    v_exp_f32 v54, v70
    v_exp_f32 v55, v71
    v_pk_fma_f32 v[56:57], v[56:57], v[42:43], v[56:57]
    v_pk_fma_f32 v[64:65], v[64:65], v[50:51], v[64:65]
    v_pk_add_f32 v[40:41], v[40:41], 1.0 op_sel_hi:[1,0]
    v_pk_add_f32 v[48:49], v[48:49], 1.0 op_sel_hi:[1,0]
    v_pk_fma_f32 v[56:57], v[58:59], v[40:41], v[56:57]
    v_pk_fma_f32 v[64:65], v[66:67], v[48:49], v[64:65]
    v_pk_fma_f32 v[40:41], v[40:41], v[42:43], v[40:41]
    v_pk_fma_f32 v[48:49], v[48:49], v[50:51], v[48:49]
    v_pk_fma_f32 v[56:57], v[56:57], v[44:45], v[56:57]
    v_pk_fma_f32 v[64:65], v[64:65], v[52:53], v[64:65]
    v_pk_fma_f32 v[56:57], v[60:61], v[40:41], v[56:57]
    v_pk_fma_f32 v[64:65], v[68:69], v[48:49], v[64:65]
    v_pk_fma_f32 v[40:41], v[40:41], v[44:45], v[40:41]
    v_pk_fma_f32 v[48:49], v[48:49], v[52:53], v[48:49]
    v_pk_fma_f32 v[56:57], v[56:57], v[46:47], v[56:57]
    v_pk_fma_f32 v[64:65], v[64:65], v[54:55], v[64:65]
    v_pk_fma_f32 v[220:221], v[62:63], v[40:41], v[56:57]
    v_pk_fma_f32 v[222:223], v[70:71], v[48:49], v[64:65]
    v_pk_fma_f32 v[216:217], v[40:41], v[46:47], v[40:41]
    v_pk_fma_f32 v[218:219], v[48:49], v[54:55], v[48:49]
    v_pk_fma_f32 v[28:29], v[216:217], v[218:219], v[28:29]
    s_waitcnt lgkmcnt(0)
    v_mfma_f32_32x32x16_bf16 v[56:71], v[88:91], v[152:155], 0
    v_rcp_f32 v216, v216
    v_rcp_f32 v217, v217
    v_rcp_f32 v218, v218
    v_rcp_f32 v219, v219
    v_mfma_f32_32x32x16_bf16 v[56:71], v[92:95], v[168:171], v[56:71]
    v_exp_f32 v40, v72
    v_exp_f32 v41, v73
    v_exp_f32 v42, v74
    v_add_u32 v27, v26, v13
    v_lshrrev_b32 v27, 14, v27
    v_lshl_add_u32 v11, v27, 5, v12
    v_add_u32 v15, v15, v241
    ds_read_b128 v[112:115], v11 offset:0
    ds_read_b128 v[116:119], v11 offset:3584
    v_mfma_f32_32x32x16_bf16 v[56:71], v[96:99], v[184:187], v[56:71]
    v_exp_f32 v43, v75
    v_exp_f32 v44, v76
    v_exp_f32 v45, v77
    ds_read_u16 v16, v1 offset:512
    ds_read_u16 v18, v1 offset:528
    ds_read_u16 v20, v1 offset:576
    ds_read_u16 v22, v1 offset:592
    ds_read_b32 v24, v2 offset:512
    v_mfma_f32_32x32x16_bf16 v[56:71], v[100:103], v[200:203], v[56:71]
    v_exp_f32 v46, v78
    v_exp_f32 v47, v79
    v_exp_f32 v48, v80
    v_mfma_f32_32x32x16_bf16 v[56:71], v[104:107], v[136:139], v[56:71]
    v_exp_f32 v49, v81
    v_exp_f32 v50, v82
    v_exp_f32 v51, v83
    v_mfma_f32_32x32x16_bf16 v[56:71], v[108:111], v[120:123], v[56:71]
    v_exp_f32 v52, v84
    v_exp_f32 v53, v85
    v_exp_f32 v54, v86
    v_exp_f32 v55, v87
    v_pk_mul_f32 v[220:221], v[220:221], v[216:217]
    v_pk_mul_f32 v[222:223], v[222:223], v[218:219]
    v_pk_fma_f32 v[72:73], v[72:73], v[42:43], v[72:73]
    v_pk_fma_f32 v[80:81], v[80:81], v[50:51], v[80:81]
    v_pk_add_f32 v[40:41], v[40:41], 1.0 op_sel_hi:[1,0]
    v_pk_add_f32 v[48:49], v[48:49], 1.0 op_sel_hi:[1,0]
    v_pk_fma_f32 v[72:73], v[74:75], v[40:41], v[72:73]
    v_pk_fma_f32 v[80:81], v[82:83], v[48:49], v[80:81]
    v_pk_fma_f32 v[40:41], v[40:41], v[42:43], v[40:41]
    v_pk_fma_f32 v[48:49], v[48:49], v[50:51], v[48:49]
    v_pk_fma_f32 v[72:73], v[72:73], v[44:45], v[72:73]
    v_pk_fma_f32 v[80:81], v[80:81], v[52:53], v[80:81]
    v_pk_fma_f32 v[72:73], v[76:77], v[40:41], v[72:73]
    v_pk_fma_f32 v[80:81], v[84:85], v[48:49], v[80:81]
    v_pk_fma_f32 v[40:41], v[40:41], v[44:45], v[40:41]
    v_pk_fma_f32 v[48:49], v[48:49], v[52:53], v[48:49]
    v_pk_fma_f32 v[72:73], v[72:73], v[46:47], v[72:73]
    v_pk_fma_f32 v[80:81], v[80:81], v[54:55], v[80:81]
    v_pk_fma_f32 v[228:229], v[78:79], v[40:41], v[72:73]
    v_pk_fma_f32 v[230:231], v[86:87], v[48:49], v[80:81]
    v_pk_fma_f32 v[224:225], v[40:41], v[46:47], v[40:41]
    v_pk_fma_f32 v[226:227], v[48:49], v[54:55], v[48:49]
    v_pk_fma_f32 v[28:29], v[224:225], v[226:227], v[28:29]
    v_mfma_f32_32x32x16_bf16 v[72:87], v[88:91], v[156:159], 0
    v_rcp_f32 v224, v224
    v_rcp_f32 v225, v225
    v_rcp_f32 v226, v226
    v_rcp_f32 v227, v227
    v_mfma_f32_32x32x16_bf16 v[72:87], v[92:95], v[172:175], v[72:87]
    v_exp_f32 v40, v56
    v_exp_f32 v41, v57
    v_exp_f32 v42, v58
    ds_read_b128 v[120:123], v11 offset:7168
    ds_read_b128 v[36:39], v4 offset:32
    v_mfma_f32_32x32x16_bf16 v[72:87], v[96:99], v[188:191], v[72:87]
    v_exp_f32 v43, v59
    v_exp_f32 v44, v60
    v_exp_f32 v45, v61
    v_mfma_f32_32x32x16_bf16 v[72:87], v[100:103], v[204:207], v[72:87]
    v_exp_f32 v46, v62
    v_exp_f32 v47, v63
    v_exp_f32 v48, v64
    v_mfma_f32_32x32x16_bf16 v[72:87], v[104:107], v[140:143], v[72:87]
    v_exp_f32 v49, v65
    v_exp_f32 v50, v66
    v_exp_f32 v51, v67
    v_mfma_f32_32x32x16_bf16 v[72:87], v[108:111], v[124:127], v[72:87]
    s_waitcnt vmcnt(1)
    ds_read_b128 v[88:91], v6
    ds_read_b128 v[92:95], v7
    ds_read_b128 v[96:99], v8
    ds_read_b128 v[100:103], v9
    ds_read_b128 v[108:111], v15 offset:1
    v_exp_f32 v52, v68
    v_exp_f32 v53, v69
    v_exp_f32 v54, v70
    v_exp_f32 v55, v71
    v_cvt_f64_f32 v[232:233], v220
    v_cvt_f64_f32 v[234:235], v221
    v_cvt_f64_f32 v[236:237], v222
    v_cvt_f64_f32 v[238:239], v223
    ds_add_f64 v32, v[232:233] offset:0
    ds_add_f64 v33, v[234:235] offset:0
    ds_add_f64 v34, v[236:237] offset:0
    ds_add_f64 v35, v[238:239] offset:0
    v_pk_mul_f32 v[228:229], v[228:229], v[224:225]
    v_pk_mul_f32 v[230:231], v[230:231], v[226:227]
    v_pk_fma_f32 v[56:57], v[56:57], v[42:43], v[56:57]
    v_pk_fma_f32 v[64:65], v[64:65], v[50:51], v[64:65]
    v_pk_add_f32 v[40:41], v[40:41], 1.0 op_sel_hi:[1,0]
    v_pk_add_f32 v[48:49], v[48:49], 1.0 op_sel_hi:[1,0]
    v_pk_fma_f32 v[56:57], v[58:59], v[40:41], v[56:57]
    v_pk_fma_f32 v[64:65], v[66:67], v[48:49], v[64:65]
    v_pk_fma_f32 v[40:41], v[40:41], v[42:43], v[40:41]
    v_pk_fma_f32 v[48:49], v[48:49], v[50:51], v[48:49]
    v_pk_fma_f32 v[56:57], v[56:57], v[44:45], v[56:57]
    v_pk_fma_f32 v[64:65], v[64:65], v[52:53], v[64:65]
    v_pk_fma_f32 v[56:57], v[60:61], v[40:41], v[56:57]
    v_pk_fma_f32 v[64:65], v[68:69], v[48:49], v[64:65]
    v_pk_fma_f32 v[40:41], v[40:41], v[44:45], v[40:41]
    v_pk_fma_f32 v[48:49], v[48:49], v[52:53], v[48:49]
    v_pk_fma_f32 v[56:57], v[56:57], v[46:47], v[56:57]
    v_pk_fma_f32 v[64:65], v[64:65], v[54:55], v[64:65]
    v_pk_fma_f32 v[220:221], v[62:63], v[40:41], v[56:57]
    v_pk_fma_f32 v[222:223], v[70:71], v[48:49], v[64:65]
    v_pk_fma_f32 v[216:217], v[40:41], v[46:47], v[40:41]
    v_pk_fma_f32 v[218:219], v[48:49], v[54:55], v[48:49]
    v_pk_fma_f32 v[28:29], v[216:217], v[218:219], v[28:29]
    s_waitcnt lgkmcnt(4)
    s_cmp_ge_u32 s37, 3
    s_cselect_b32 s6, 10000, 0
    s_cselect_b32 s10, 640000, 0
    v_mfma_f32_32x32x16_bf16 v[56:71], v[88:91], v[144:147], 0
    s_add_u32 m0, s36, 0
    s_nop 0
    buffer_load_dwordx4 v[16:17], s[4:7], 0 idxen offen lds
    v_rcp_f32 v216, v216
    v_rcp_f32 v217, v217
    v_rcp_f32 v218, v218
    v_rcp_f32 v219, v219
    v_mfma_f32_32x32x16_bf16 v[56:71], v[92:95], v[160:163], v[56:71]
    s_add_u32 m0, s36, 1024
    s_nop 0
    buffer_load_dwordx4 v[18:19], s[4:7], 0 idxen offen lds
    v_exp_f32 v40, v72
    v_exp_f32 v41, v73
    v_exp_f32 v42, v74
    ds_read_b128 v[124:127], v11 offset:10752
    v_mfma_f32_32x32x16_bf16 v[56:71], v[96:99], v[176:179], v[56:71]
    s_add_u32 m0, s36, 2048
    s_nop 0
    buffer_load_dwordx4 v[20:21], s[4:7], 0 idxen offen lds
    v_exp_f32 v43, v75
    v_exp_f32 v44, v76
    v_exp_f32 v45, v77
    v_cmp_ne_u32 vcc, v36, v39
    v_mfma_f32_32x32x16_bf16 v[56:71], v[100:103], v[192:195], v[56:71]
    s_add_u32 m0, s36, 3072
    s_nop 0
    buffer_load_dwordx4 v[22:23], s[4:7], 0 idxen offen lds
    v_exp_f32 v46, v78
    v_exp_f32 v47, v79
    v_exp_f32 v48, v80
    s_cmp_eq_u64 vcc, 0
    s_cselect_b32 s29, 1, 0
    s_waitcnt vmcnt(4)
    v_mfma_f32_32x32x16_bf16 v[56:71], v[248:251], v[128:131], v[56:71]
    buffer_load_dwordx4 v[104:107], v[24:25], s[8:11], 0 idxen offen
    v_exp_f32 v49, v81
    v_exp_f32 v50, v82
    v_exp_f32 v51, v83
    v_mfma_f32_32x32x16_bf16 v[56:71], v[108:111], v[112:115], v[56:71]
    v_exp_f32 v52, v84
    v_exp_f32 v53, v85
    v_exp_f32 v54, v86
    v_exp_f32 v55, v87
    v_cvt_f64_f32 v[232:233], v228
    v_cvt_f64_f32 v[234:235], v229
    v_cvt_f64_f32 v[236:237], v230
    v_cvt_f64_f32 v[238:239], v231
    ds_add_f64 v32, v[232:233] offset:256
    ds_add_f64 v33, v[234:235] offset:256
    ds_add_f64 v34, v[236:237] offset:256
    ds_add_f64 v35, v[238:239] offset:256
    v_pk_mul_f32 v[220:221], v[220:221], v[216:217]
    v_pk_mul_f32 v[222:223], v[222:223], v[218:219]
    v_pk_fma_f32 v[72:73], v[72:73], v[42:43], v[72:73]
    v_pk_fma_f32 v[80:81], v[80:81], v[50:51], v[80:81]
    v_pk_add_f32 v[40:41], v[40:41], 1.0 op_sel_hi:[1,0]
    v_pk_add_f32 v[48:49], v[48:49], 1.0 op_sel_hi:[1,0]
    v_pk_fma_f32 v[72:73], v[74:75], v[40:41], v[72:73]
    v_pk_fma_f32 v[80:81], v[82:83], v[48:49], v[80:81]
    v_pk_fma_f32 v[40:41], v[40:41], v[42:43], v[40:41]
    v_pk_fma_f32 v[48:49], v[48:49], v[50:51], v[48:49]
    v_pk_fma_f32 v[72:73], v[72:73], v[44:45], v[72:73]
    v_pk_fma_f32 v[80:81], v[80:81], v[52:53], v[80:81]
    v_pk_fma_f32 v[72:73], v[76:77], v[40:41], v[72:73]
    v_pk_fma_f32 v[80:81], v[84:85], v[48:49], v[80:81]
    v_pk_fma_f32 v[40:41], v[40:41], v[44:45], v[40:41]
    v_pk_fma_f32 v[48:49], v[48:49], v[52:53], v[48:49]
    v_pk_fma_f32 v[72:73], v[72:73], v[46:47], v[72:73]
    v_pk_fma_f32 v[80:81], v[80:81], v[54:55], v[80:81]
    v_pk_fma_f32 v[228:229], v[78:79], v[40:41], v[72:73]
    v_pk_fma_f32 v[230:231], v[86:87], v[48:49], v[80:81]
    v_pk_fma_f32 v[224:225], v[40:41], v[46:47], v[40:41]
    v_pk_fma_f32 v[226:227], v[48:49], v[54:55], v[48:49]
    v_pk_fma_f32 v[28:29], v[224:225], v[226:227], v[28:29]
    s_sub_u32 s37, s37, 1
    s_cmp_eq_u32 s37, 1
    s_cbranch_scc0 B_W2T010
    s_mov_b32 s16, s60
    s_and_b32 s17, s61, 0xffff
    s_mov_b32 s18, 16384
    s_mov_b32 s19, 0x20000
    v_lshlrev_b32 v247, 4, v211
    s_lshl_b32 s24, s32, 11
    s_add_u32 m0, s24, 140544
    s_add_u32 s25, s24, 0
    buffer_load_dwordx4 v247, s[16:19], s25 offen lds
    s_add_u32 m0, s24, 141568
    s_add_u32 s25, s24, 1024
    buffer_load_dwordx4 v247, s[16:19], s25 offen lds
    s_mov_b32 s16, s62
    s_and_b32 s17, s63, 0xffff
    s_mov_b32 s18, 128
    s_mov_b32 s19, 0x20000
    s_mov_b32 m0, 156928
    s_nop 0
    buffer_load_dwordx4 v247, s[16:19], 0 offen lds
B_W2T010:
    s_cmp_eq_u32 s37, 2
    s_cbranch_scc0 B_PT0102
    s_setprio 1
B_PT0102:
    s_cmp_eq_u32 s37, 1
    s_cbranch_scc0 B_PT0101
    s_setprio 0
B_PT0101:
    s_cmp_eq_u32 s37, 0
    s_cbranch_scc1 B_DRAIN00
    s_cmp_eq_u32 s29, 0
    s_cbranch_scc0 B_T101
    s_branch B_T100
B_T001:
    v_mfma_f32_32x32x16_bf16 v[72:87], v[88:91], v[148:151], 0
    v_rcp_f32 v224, v224
    v_rcp_f32 v225, v225
    v_rcp_f32 v226, v226
    v_rcp_f32 v227, v227
    v_mfma_f32_32x32x16_bf16 v[72:87], v[92:95], v[164:167], v[72:87]
    v_exp_f32 v40, v56
    v_exp_f32 v41, v57
    v_exp_f32 v42, v58
    ds_read_b32 v26, v5 offset:32
    ds_read_u16 v15, v3 offset:256
    v_mfma_f32_32x32x16_bf16 v[72:87], v[96:99], v[180:183], v[72:87]
    v_exp_f32 v43, v59
    v_exp_f32 v44, v60
    v_exp_f32 v45, v61
    v_add_u32 v32, v32, v14
    v_mfma_f32_32x32x16_bf16 v[72:87], v[100:103], v[196:199], v[72:87]
    v_exp_f32 v46, v62
    v_exp_f32 v47, v63
    v_exp_f32 v48, v64
    v_mfma_f32_32x32x16_bf16 v[72:87], v[104:107], v[132:135], v[72:87]
    v_exp_f32 v49, v65
    v_exp_f32 v50, v66
    v_exp_f32 v51, v67
    v_mfma_f32_32x32x16_bf16 v[72:87], v[108:111], v[116:119], v[72:87]
    v_exp_f32 v52, v68
    v_exp_f32 v53, v69
    v_exp_f32 v54, v70
    v_exp_f32 v55, v71
    v_cvt_f64_f32 v[232:233], v220
    v_cvt_f64_f32 v[234:235], v221
    v_cvt_f64_f32 v[236:237], v222
    v_cvt_f64_f32 v[238:239], v223
    ds_add_f64 v36, v[232:233] offset:512
    ds_add_f64 v37, v[234:235] offset:512
    ds_add_f64 v38, v[236:237] offset:512
    ds_add_f64 v39, v[238:239] offset:512
    v_pk_mul_f32 v[228:229], v[228:229], v[224:225]
    v_pk_mul_f32 v[230:231], v[230:231], v[226:227]
    v_pk_fma_f32 v[56:57], v[56:57], v[42:43], v[56:57]
    v_pk_fma_f32 v[64:65], v[64:65], v[50:51], v[64:65]
    v_pk_add_f32 v[40:41], v[40:41], 1.0 op_sel_hi:[1,0]
    v_pk_add_f32 v[48:49], v[48:49], 1.0 op_sel_hi:[1,0]
    v_pk_fma_f32 v[56:57], v[58:59], v[40:41], v[56:57]
    v_pk_fma_f32 v[64:65], v[66:67], v[48:49], v[64:65]
    v_pk_fma_f32 v[40:41], v[40:41], v[42:43], v[40:41]
    v_pk_fma_f32 v[48:49], v[48:49], v[50:51], v[48:49]
    v_pk_fma_f32 v[56:57], v[56:57], v[44:45], v[56:57]
    v_pk_fma_f32 v[64:65], v[64:65], v[52:53], v[64:65]
    v_pk_fma_f32 v[56:57], v[60:61], v[40:41], v[56:57]
    v_pk_fma_f32 v[64:65], v[68:69], v[48:49], v[64:65]
    v_pk_fma_f32 v[40:41], v[40:41], v[44:45], v[40:41]
    v_pk_fma_f32 v[48:49], v[48:49], v[52:53], v[48:49]
    v_pk_fma_f32 v[56:57], v[56:57], v[46:47], v[56:57]
    v_pk_fma_f32 v[64:65], v[64:65], v[54:55], v[64:65]
    v_pk_fma_f32 v[220:221], v[62:63], v[40:41], v[56:57]
    v_pk_fma_f32 v[222:223], v[70:71], v[48:49], v[64:65]
    v_pk_fma_f32 v[216:217], v[40:41], v[46:47], v[40:41]
    v_pk_fma_f32 v[218:219], v[48:49], v[54:55], v[48:49]
    v_pk_mul_f32 v[236:237], v[220:221], v[218:219]
    v_pk_fma_f32 v[220:221], v[222:223], v[216:217], v[236:237]
    v_pk_mul_f32 v[216:217], v[216:217], v[218:219]
    s_waitcnt lgkmcnt(4)
    v_mfma_f32_32x32x16_bf16 v[56:71], v[88:91], v[152:155], 0
    v_mul_f32 v218, v216, v217
    v_mul_f32 v222, v220, v217
    v_fma_f32 v222, v221, v216, v222
    v_rcp_f32 v219, v218
    v_add_f32 v28, v28, v218
    v_mul_f32 v222, v222, v219
    v_cvt_f64_f32 v[232:233], v222
    ds_add_f64 v32, v[232:233] offset:0
    v_mfma_f32_32x32x16_bf16 v[56:71], v[92:95], v[168:171], v[56:71]
    v_exp_f32 v40, v72
    v_exp_f32 v41, v73
    v_exp_f32 v42, v74
    v_add_u32 v27, v26, v13
    v_lshrrev_b32 v27, 14, v27
    v_lshl_add_u32 v11, v27, 5, v12
    v_add_u32 v15, v15, v241
    ds_read_b128 v[112:115], v11 offset:0
    ds_read_b128 v[116:119], v11 offset:3584
    v_mfma_f32_32x32x16_bf16 v[56:71], v[96:99], v[184:187], v[56:71]
    v_exp_f32 v43, v75
    v_exp_f32 v44, v76
    v_exp_f32 v45, v77
    ds_read_u16 v16, v1 offset:512
    ds_read_u16 v18, v1 offset:528
    ds_read_u16 v20, v1 offset:576
    ds_read_u16 v22, v1 offset:592
    ds_read_b32 v24, v2 offset:512
    v_mfma_f32_32x32x16_bf16 v[56:71], v[100:103], v[200:203], v[56:71]
    v_exp_f32 v46, v78
    v_exp_f32 v47, v79
    v_exp_f32 v48, v80
    v_mfma_f32_32x32x16_bf16 v[56:71], v[104:107], v[136:139], v[56:71]
    v_exp_f32 v49, v81
    v_exp_f32 v50, v82
    v_exp_f32 v51, v83
    v_mfma_f32_32x32x16_bf16 v[56:71], v[108:111], v[120:123], v[56:71]
    v_exp_f32 v52, v84
    v_exp_f32 v53, v85
    v_exp_f32 v54, v86
    v_exp_f32 v55, v87
    v_cvt_f64_f32 v[232:233], v228
    v_cvt_f64_f32 v[234:235], v229
    v_cvt_f64_f32 v[236:237], v230
    v_cvt_f64_f32 v[238:239], v231
    ds_add_f64 v36, v[232:233] offset:768
    ds_add_f64 v37, v[234:235] offset:768
    ds_add_f64 v38, v[236:237] offset:768
    ds_add_f64 v39, v[238:239] offset:768
    v_pk_fma_f32 v[72:73], v[72:73], v[42:43], v[72:73]
    v_pk_fma_f32 v[80:81], v[80:81], v[50:51], v[80:81]
    v_pk_add_f32 v[40:41], v[40:41], 1.0 op_sel_hi:[1,0]
    v_pk_add_f32 v[48:49], v[48:49], 1.0 op_sel_hi:[1,0]
    v_pk_fma_f32 v[72:73], v[74:75], v[40:41], v[72:73]
    v_pk_fma_f32 v[80:81], v[82:83], v[48:49], v[80:81]
    v_pk_fma_f32 v[40:41], v[40:41], v[42:43], v[40:41]
    v_pk_fma_f32 v[48:49], v[48:49], v[50:51], v[48:49]
    v_pk_fma_f32 v[72:73], v[72:73], v[44:45], v[72:73]
    v_pk_fma_f32 v[80:81], v[80:81], v[52:53], v[80:81]
    v_pk_fma_f32 v[72:73], v[76:77], v[40:41], v[72:73]
    v_pk_fma_f32 v[80:81], v[84:85], v[48:49], v[80:81]
    v_pk_fma_f32 v[40:41], v[40:41], v[44:45], v[40:41]
    v_pk_fma_f32 v[48:49], v[48:49], v[52:53], v[48:49]
    v_pk_fma_f32 v[72:73], v[72:73], v[46:47], v[72:73]
    v_pk_fma_f32 v[80:81], v[80:81], v[54:55], v[80:81]
    v_pk_fma_f32 v[228:229], v[78:79], v[40:41], v[72:73]
    v_pk_fma_f32 v[230:231], v[86:87], v[48:49], v[80:81]
    v_pk_fma_f32 v[224:225], v[40:41], v[46:47], v[40:41]
    v_pk_fma_f32 v[226:227], v[48:49], v[54:55], v[48:49]
    v_pk_mul_f32 v[236:237], v[228:229], v[226:227]
    v_pk_fma_f32 v[228:229], v[230:231], v[224:225], v[236:237]
    v_pk_mul_f32 v[224:225], v[224:225], v[226:227]
    v_mfma_f32_32x32x16_bf16 v[72:87], v[88:91], v[156:159], 0
    v_mul_f32 v226, v224, v225
    v_mul_f32 v230, v228, v225
    v_fma_f32 v230, v229, v224, v230
    v_rcp_f32 v227, v226
    v_add_f32 v28, v28, v226
    v_mul_f32 v230, v230, v227
    v_cvt_f64_f32 v[232:233], v230
    ds_add_f64 v32, v[232:233] offset:256
    v_mfma_f32_32x32x16_bf16 v[72:87], v[92:95], v[172:175], v[72:87]
    v_exp_f32 v40, v56
    v_exp_f32 v41, v57
    v_exp_f32 v42, v58
    ds_read_b128 v[120:123], v11 offset:7168
    ds_read_b128 v[36:39], v4 offset:32
    v_mfma_f32_32x32x16_bf16 v[72:87], v[96:99], v[188:191], v[72:87]
    v_exp_f32 v43, v59
    v_exp_f32 v44, v60
    v_exp_f32 v45, v61
    v_mfma_f32_32x32x16_bf16 v[72:87], v[100:103], v[204:207], v[72:87]
    v_exp_f32 v46, v62
    v_exp_f32 v47, v63
    v_exp_f32 v48, v64
    v_mfma_f32_32x32x16_bf16 v[72:87], v[104:107], v[140:143], v[72:87]
    v_exp_f32 v49, v65
    v_exp_f32 v50, v66
    v_exp_f32 v51, v67
    v_mfma_f32_32x32x16_bf16 v[72:87], v[108:111], v[124:127], v[72:87]
    s_waitcnt vmcnt(1)
    ds_read_b128 v[88:91], v6
    ds_read_b128 v[92:95], v7
    ds_read_b128 v[96:99], v8
    ds_read_b128 v[100:103], v9
    ds_read_b128 v[108:111], v15 offset:1
    v_exp_f32 v52, v68
    v_exp_f32 v53, v69
    v_exp_f32 v54, v70
    v_exp_f32 v55, v71
    v_pk_fma_f32 v[56:57], v[56:57], v[42:43], v[56:57]
    v_pk_fma_f32 v[64:65], v[64:65], v[50:51], v[64:65]
    v_pk_add_f32 v[40:41], v[40:41], 1.0 op_sel_hi:[1,0]
    v_pk_add_f32 v[48:49], v[48:49], 1.0 op_sel_hi:[1,0]
    v_pk_fma_f32 v[56:57], v[58:59], v[40:41], v[56:57]
    v_pk_fma_f32 v[64:65], v[66:67], v[48:49], v[64:65]
    v_pk_fma_f32 v[40:41], v[40:41], v[42:43], v[40:41]
    v_pk_fma_f32 v[48:49], v[48:49], v[50:51], v[48:49]
    v_pk_fma_f32 v[56:57], v[56:57], v[44:45], v[56:57]
    v_pk_fma_f32 v[64:65], v[64:65], v[52:53], v[64:65]
    v_pk_fma_f32 v[56:57], v[60:61], v[40:41], v[56:57]
    v_pk_fma_f32 v[64:65], v[68:69], v[48:49], v[64:65]
    v_pk_fma_f32 v[40:41], v[40:41], v[44:45], v[40:41]
    v_pk_fma_f32 v[48:49], v[48:49], v[52:53], v[48:49]
    v_pk_fma_f32 v[56:57], v[56:57], v[46:47], v[56:57]
    v_pk_fma_f32 v[64:65], v[64:65], v[54:55], v[64:65]
    v_pk_fma_f32 v[220:221], v[62:63], v[40:41], v[56:57]
    v_pk_fma_f32 v[222:223], v[70:71], v[48:49], v[64:65]
    v_pk_fma_f32 v[216:217], v[40:41], v[46:47], v[40:41]
    v_pk_fma_f32 v[218:219], v[48:49], v[54:55], v[48:49]
    v_pk_mul_f32 v[236:237], v[220:221], v[218:219]
    v_pk_fma_f32 v[220:221], v[222:223], v[216:217], v[236:237]
    v_pk_mul_f32 v[216:217], v[216:217], v[218:219]
    s_waitcnt lgkmcnt(0)
    s_cmp_ge_u32 s37, 3
    s_cselect_b32 s6, 10000, 0
    s_cselect_b32 s10, 640000, 0
    v_mfma_f32_32x32x16_bf16 v[56:71], v[88:91], v[144:147], 0
    s_add_u32 m0, s36, 0
    s_nop 0
    buffer_load_dwordx4 v[16:17], s[4:7], 0 idxen offen lds
    v_mul_f32 v218, v216, v217
    v_mul_f32 v222, v220, v217
    v_fma_f32 v222, v221, v216, v222
    v_rcp_f32 v219, v218
    v_add_f32 v28, v28, v218
    v_mul_f32 v222, v222, v219
    v_cvt_f64_f32 v[232:233], v222
    ds_add_f64 v32, v[232:233] offset:512
    v_mfma_f32_32x32x16_bf16 v[56:71], v[92:95], v[160:163], v[56:71]
    s_add_u32 m0, s36, 1024
    s_nop 0
    buffer_load_dwordx4 v[18:19], s[4:7], 0 idxen offen lds
    v_exp_f32 v40, v72
    v_exp_f32 v41, v73
    v_exp_f32 v42, v74
    ds_read_b128 v[124:127], v11 offset:10752
    v_mfma_f32_32x32x16_bf16 v[56:71], v[96:99], v[176:179], v[56:71]
    s_add_u32 m0, s36, 2048
    s_nop 0
    buffer_load_dwordx4 v[20:21], s[4:7], 0 idxen offen lds
    v_exp_f32 v43, v75
    v_exp_f32 v44, v76
    v_exp_f32 v45, v77
    v_cmp_ne_u32 vcc, v36, v39
    v_mfma_f32_32x32x16_bf16 v[56:71], v[100:103], v[192:195], v[56:71]
    s_add_u32 m0, s36, 3072
    s_nop 0
    buffer_load_dwordx4 v[22:23], s[4:7], 0 idxen offen lds
    v_exp_f32 v46, v78
    v_exp_f32 v47, v79
    v_exp_f32 v48, v80
    s_cmp_eq_u64 vcc, 0
    s_cselect_b32 s29, 1, 0
    s_waitcnt vmcnt(4)
    v_mfma_f32_32x32x16_bf16 v[56:71], v[248:251], v[128:131], v[56:71]
    buffer_load_dwordx4 v[104:107], v[24:25], s[8:11], 0 idxen offen
    v_exp_f32 v49, v81
    v_exp_f32 v50, v82
    v_exp_f32 v51, v83
    v_mfma_f32_32x32x16_bf16 v[56:71], v[108:111], v[112:115], v[56:71]
    v_exp_f32 v52, v84
    v_exp_f32 v53, v85
    v_exp_f32 v54, v86
    v_exp_f32 v55, v87
    v_pk_fma_f32 v[72:73], v[72:73], v[42:43], v[72:73]
    v_pk_fma_f32 v[80:81], v[80:81], v[50:51], v[80:81]
    v_pk_add_f32 v[40:41], v[40:41], 1.0 op_sel_hi:[1,0]
    v_pk_add_f32 v[48:49], v[48:49], 1.0 op_sel_hi:[1,0]
    v_pk_fma_f32 v[72:73], v[74:75], v[40:41], v[72:73]
    v_pk_fma_f32 v[80:81], v[82:83], v[48:49], v[80:81]
    v_pk_fma_f32 v[40:41], v[40:41], v[42:43], v[40:41]
    v_pk_fma_f32 v[48:49], v[48:49], v[50:51], v[48:49]
    v_pk_fma_f32 v[72:73], v[72:73], v[44:45], v[72:73]
    v_pk_fma_f32 v[80:81], v[80:81], v[52:53], v[80:81]
    v_pk_fma_f32 v[72:73], v[76:77], v[40:41], v[72:73]
    v_pk_fma_f32 v[80:81], v[84:85], v[48:49], v[80:81]
    v_pk_fma_f32 v[40:41], v[40:41], v[44:45], v[40:41]
    v_pk_fma_f32 v[48:49], v[48:49], v[52:53], v[48:49]
    v_pk_fma_f32 v[72:73], v[72:73], v[46:47], v[72:73]
    v_pk_fma_f32 v[80:81], v[80:81], v[54:55], v[80:81]
    v_pk_fma_f32 v[228:229], v[78:79], v[40:41], v[72:73]
    v_pk_fma_f32 v[230:231], v[86:87], v[48:49], v[80:81]
    v_pk_fma_f32 v[224:225], v[40:41], v[46:47], v[40:41]
    v_pk_fma_f32 v[226:227], v[48:49], v[54:55], v[48:49]
    v_pk_mul_f32 v[236:237], v[228:229], v[226:227]
    v_pk_fma_f32 v[228:229], v[230:231], v[224:225], v[236:237]
    v_pk_mul_f32 v[224:225], v[224:225], v[226:227]
    s_sub_u32 s37, s37, 1
    s_cmp_eq_u32 s37, 1
    s_cbranch_scc0 B_W2T001
    s_mov_b32 s16, s60
    s_and_b32 s17, s61, 0xffff
    s_mov_b32 s18, 16384
    s_mov_b32 s19, 0x20000
    v_lshlrev_b32 v247, 4, v211
    s_lshl_b32 s24, s32, 11
    s_add_u32 m0, s24, 140544
    s_add_u32 s25, s24, 0
    buffer_load_dwordx4 v247, s[16:19], s25 offen lds
    s_add_u32 m0, s24, 141568
    s_add_u32 s25, s24, 1024
    buffer_load_dwordx4 v247, s[16:19], s25 offen lds
    s_mov_b32 s16, s62
    s_and_b32 s17, s63, 0xffff
    s_mov_b32 s18, 128
    s_mov_b32 s19, 0x20000
    s_mov_b32 m0, 156928
    s_nop 0
    buffer_load_dwordx4 v247, s[16:19], 0 offen lds
B_W2T001:
    s_cmp_eq_u32 s37, 2
    s_cbranch_scc0 B_PT0012
    s_setprio 1
B_PT0012:
    s_cmp_eq_u32 s37, 1
    s_cbranch_scc0 B_PT0011
    s_setprio 0
B_PT0011:
    s_cmp_eq_u32 s37, 0
    s_cbranch_scc1 B_DRAIN01
    s_cmp_eq_u32 s29, 0
    s_cbranch_scc1 B_T110
B_T111:
    v_mfma_f32_32x32x16_bf16 v[72:87], v[88:91], v[148:151], 0
    v_mul_f32 v226, v224, v225
    v_mul_f32 v230, v228, v225
    v_fma_f32 v230, v229, v224, v230
    v_rcp_f32 v227, v226
    v_add_f32 v28, v28, v226
    v_mul_f32 v230, v230, v227
    v_cvt_f64_f32 v[232:233], v230
    ds_add_f64 v32, v[232:233] offset:768
    v_mfma_f32_32x32x16_bf16 v[72:87], v[92:95], v[164:167], v[72:87]
    v_exp_f32 v40, v56
    v_exp_f32 v41, v57
    v_exp_f32 v42, v58
    ds_read_b32 v26, v5 offset:64
    ds_read_u16 v15, v3 offset:512
    v_mfma_f32_32x32x16_bf16 v[72:87], v[96:99], v[180:183], v[72:87]
    v_exp_f32 v43, v59
    v_exp_f32 v44, v60
    v_exp_f32 v45, v61
    v_add_u32 v36, v36, v14
    v_mfma_f32_32x32x16_bf16 v[72:87], v[100:103], v[196:199], v[72:87]
    v_exp_f32 v46, v62
    v_exp_f32 v47, v63
    v_exp_f32 v48, v64
    v_mfma_f32_32x32x16_bf16 v[72:87], v[248:251], v[132:135], v[72:87]
    v_exp_f32 v49, v65
    v_exp_f32 v50, v66
    v_exp_f32 v51, v67
    v_mfma_f32_32x32x16_bf16 v[72:87], v[108:111], v[116:119], v[72:87]
    v_exp_f32 v52, v68
    v_exp_f32 v53, v69
    v_exp_f32 v54, v70
    v_exp_f32 v55, v71
    v_pk_fma_f32 v[56:57], v[56:57], v[42:43], v[56:57]
    v_pk_fma_f32 v[64:65], v[64:65], v[50:51], v[64:65]
    v_pk_add_f32 v[40:41], v[40:41], 1.0 op_sel_hi:[1,0]
    v_pk_add_f32 v[48:49], v[48:49], 1.0 op_sel_hi:[1,0]
    v_pk_fma_f32 v[56:57], v[58:59], v[40:41], v[56:57]
    v_pk_fma_f32 v[64:65], v[66:67], v[48:49], v[64:65]
    v_pk_fma_f32 v[40:41], v[40:41], v[42:43], v[40:41]
    v_pk_fma_f32 v[48:49], v[48:49], v[50:51], v[48:49]
    v_pk_fma_f32 v[56:57], v[56:57], v[44:45], v[56:57]
    v_pk_fma_f32 v[64:65], v[64:65], v[52:53], v[64:65]
    v_pk_fma_f32 v[56:57], v[60:61], v[40:41], v[56:57]
    v_pk_fma_f32 v[64:65], v[68:69], v[48:49], v[64:65]
    v_pk_fma_f32 v[40:41], v[40:41], v[44:45], v[40:41]
    v_pk_fma_f32 v[48:49], v[48:49], v[52:53], v[48:49]
    v_pk_fma_f32 v[56:57], v[56:57], v[46:47], v[56:57]
    v_pk_fma_f32 v[64:65], v[64:65], v[54:55], v[64:65]
    v_pk_fma_f32 v[220:221], v[62:63], v[40:41], v[56:57]
    v_pk_fma_f32 v[222:223], v[70:71], v[48:49], v[64:65]
    v_pk_fma_f32 v[216:217], v[40:41], v[46:47], v[40:41]
    v_pk_fma_f32 v[218:219], v[48:49], v[54:55], v[48:49]
    v_pk_mul_f32 v[236:237], v[220:221], v[218:219]
    v_pk_fma_f32 v[220:221], v[222:223], v[216:217], v[236:237]
    v_pk_mul_f32 v[216:217], v[216:217], v[218:219]
    s_waitcnt lgkmcnt(0)
    v_mfma_f32_32x32x16_bf16 v[56:71], v[88:91], v[152:155], 0
    v_mul_f32 v218, v216, v217
    v_mul_f32 v222, v220, v217
    v_fma_f32 v222, v221, v216, v222
    v_rcp_f32 v219, v218
    v_add_f32 v28, v28, v218
    v_mul_f32 v222, v222, v219
    v_cvt_f64_f32 v[232:233], v222
    ds_add_f64 v36, v[232:233] offset:0
    v_mfma_f32_32x32x16_bf16 v[56:71], v[92:95], v[168:171], v[56:71]
    v_exp_f32 v40, v72
    v_exp_f32 v41, v73
    v_exp_f32 v42, v74
    v_add_u32 v27, v26, v13
    v_lshrrev_b32 v27, 14, v27
    v_lshl_add_u32 v11, v27, 5, v12
    v_add_u32 v15, v15, v241
    ds_read_b128 v[112:115], v11 offset:0
    ds_read_b128 v[116:119], v11 offset:3584
    v_mfma_f32_32x32x16_bf16 v[56:71], v[96:99], v[184:187], v[56:71]
    v_exp_f32 v43, v75
    v_exp_f32 v44, v76
    v_exp_f32 v45, v77
    ds_read_u16 v16, v1 offset:768
    ds_read_u16 v18, v1 offset:784
    ds_read_u16 v20, v1 offset:832
    ds_read_u16 v22, v1 offset:848
    ds_read_b32 v24, v2 offset:768
    v_mfma_f32_32x32x16_bf16 v[56:71], v[100:103], v[200:203], v[56:71]
    v_exp_f32 v46, v78
    v_exp_f32 v47, v79
    v_exp_f32 v48, v80
    v_mfma_f32_32x32x16_bf16 v[56:71], v[248:251], v[136:139], v[56:71]
    v_exp_f32 v49, v81
    v_exp_f32 v50, v82
    v_exp_f32 v51, v83
    v_mfma_f32_32x32x16_bf16 v[56:71], v[108:111], v[120:123], v[56:71]
    v_exp_f32 v52, v84
    v_exp_f32 v53, v85
    v_exp_f32 v54, v86
    v_exp_f32 v55, v87
    v_pk_fma_f32 v[72:73], v[72:73], v[42:43], v[72:73]
    v_pk_fma_f32 v[80:81], v[80:81], v[50:51], v[80:81]
    v_pk_add_f32 v[40:41], v[40:41], 1.0 op_sel_hi:[1,0]
    v_pk_add_f32 v[48:49], v[48:49], 1.0 op_sel_hi:[1,0]
    v_pk_fma_f32 v[72:73], v[74:75], v[40:41], v[72:73]
    v_pk_fma_f32 v[80:81], v[82:83], v[48:49], v[80:81]
    v_pk_fma_f32 v[40:41], v[40:41], v[42:43], v[40:41]
    v_pk_fma_f32 v[48:49], v[48:49], v[50:51], v[48:49]
    v_pk_fma_f32 v[72:73], v[72:73], v[44:45], v[72:73]
    v_pk_fma_f32 v[80:81], v[80:81], v[52:53], v[80:81]
    v_pk_fma_f32 v[72:73], v[76:77], v[40:41], v[72:73]
    v_pk_fma_f32 v[80:81], v[84:85], v[48:49], v[80:81]
    v_pk_fma_f32 v[40:41], v[40:41], v[44:45], v[40:41]
    v_pk_fma_f32 v[48:49], v[48:49], v[52:53], v[48:49]
    v_pk_fma_f32 v[72:73], v[72:73], v[46:47], v[72:73]
    v_pk_fma_f32 v[80:81], v[80:81], v[54:55], v[80:81]
    v_pk_fma_f32 v[228:229], v[78:79], v[40:41], v[72:73]
    v_pk_fma_f32 v[230:231], v[86:87], v[48:49], v[80:81]
    v_pk_fma_f32 v[224:225], v[40:41], v[46:47], v[40:41]
    v_pk_fma_f32 v[226:227], v[48:49], v[54:55], v[48:49]
    v_pk_mul_f32 v[236:237], v[228:229], v[226:227]
    v_pk_fma_f32 v[228:229], v[230:231], v[224:225], v[236:237]
    v_pk_mul_f32 v[224:225], v[224:225], v[226:227]
    v_mfma_f32_32x32x16_bf16 v[72:87], v[88:91], v[156:159], 0
    v_mul_f32 v226, v224, v225
    v_mul_f32 v230, v228, v225
    v_fma_f32 v230, v229, v224, v230
    v_rcp_f32 v227, v226
    v_add_f32 v28, v28, v226
    v_mul_f32 v230, v230, v227
    v_cvt_f64_f32 v[232:233], v230
    ds_add_f64 v36, v[232:233] offset:256
    v_mfma_f32_32x32x16_bf16 v[72:87], v[92:95], v[172:175], v[72:87]
    v_exp_f32 v40, v56
    v_exp_f32 v41, v57
    v_exp_f32 v42, v58
    ds_read_b128 v[120:123], v11 offset:7168
    ds_read_b128 v[32:35], v4 offset:64
    v_mfma_f32_32x32x16_bf16 v[72:87], v[96:99], v[188:191], v[72:87]
    v_exp_f32 v43, v59
    v_exp_f32 v44, v60
    v_exp_f32 v45, v61
    v_mfma_f32_32x32x16_bf16 v[72:87], v[100:103], v[204:207], v[72:87]
    v_exp_f32 v46, v62
    v_exp_f32 v47, v63
    v_exp_f32 v48, v64
    v_mfma_f32_32x32x16_bf16 v[72:87], v[248:251], v[140:143], v[72:87]
    v_exp_f32 v49, v65
    v_exp_f32 v50, v66
    v_exp_f32 v51, v67
    v_mfma_f32_32x32x16_bf16 v[72:87], v[108:111], v[124:127], v[72:87]
    s_waitcnt vmcnt(1)
    ds_read_b128 v[88:91], v6
    ds_read_b128 v[92:95], v7
    ds_read_b128 v[96:99], v8
    ds_read_b128 v[100:103], v9
    ds_read_b128 v[108:111], v15 offset:1
    v_exp_f32 v52, v68
    v_exp_f32 v53, v69
    v_exp_f32 v54, v70
    v_exp_f32 v55, v71
    v_pk_fma_f32 v[56:57], v[56:57], v[42:43], v[56:57]
    v_pk_fma_f32 v[64:65], v[64:65], v[50:51], v[64:65]
    v_pk_add_f32 v[40:41], v[40:41], 1.0 op_sel_hi:[1,0]
    v_pk_add_f32 v[48:49], v[48:49], 1.0 op_sel_hi:[1,0]
    v_pk_fma_f32 v[56:57], v[58:59], v[40:41], v[56:57]
    v_pk_fma_f32 v[64:65], v[66:67], v[48:49], v[64:65]
    v_pk_fma_f32 v[40:41], v[40:41], v[42:43], v[40:41]
    v_pk_fma_f32 v[48:49], v[48:49], v[50:51], v[48:49]
    v_pk_fma_f32 v[56:57], v[56:57], v[44:45], v[56:57]
    v_pk_fma_f32 v[64:65], v[64:65], v[52:53], v[64:65]
    v_pk_fma_f32 v[56:57], v[60:61], v[40:41], v[56:57]
    v_pk_fma_f32 v[64:65], v[68:69], v[48:49], v[64:65]
    v_pk_fma_f32 v[40:41], v[40:41], v[44:45], v[40:41]
    v_pk_fma_f32 v[48:49], v[48:49], v[52:53], v[48:49]
    v_pk_fma_f32 v[56:57], v[56:57], v[46:47], v[56:57]
    v_pk_fma_f32 v[64:65], v[64:65], v[54:55], v[64:65]
    v_pk_fma_f32 v[220:221], v[62:63], v[40:41], v[56:57]
    v_pk_fma_f32 v[222:223], v[70:71], v[48:49], v[64:65]
    v_pk_fma_f32 v[216:217], v[40:41], v[46:47], v[40:41]
    v_pk_fma_f32 v[218:219], v[48:49], v[54:55], v[48:49]
    v_pk_mul_f32 v[236:237], v[220:221], v[218:219]
    v_pk_fma_f32 v[220:221], v[222:223], v[216:217], v[236:237]
    v_pk_mul_f32 v[216:217], v[216:217], v[218:219]
    s_waitcnt lgkmcnt(0)
    s_cmp_ge_u32 s37, 3
    s_cselect_b32 s6, 10000, 0
    s_cselect_b32 s10, 640000, 0
    v_mfma_f32_32x32x16_bf16 v[56:71], v[88:91], v[144:147], 0
    s_add_u32 m0, s36, 0
    s_nop 0
    buffer_load_dwordx4 v[16:17], s[4:7], 0 idxen offen lds
    v_mul_f32 v218, v216, v217
    v_mul_f32 v222, v220, v217
    v_fma_f32 v222, v221, v216, v222
    v_rcp_f32 v219, v218
    v_add_f32 v28, v28, v218
    v_mul_f32 v222, v222, v219
    v_cvt_f64_f32 v[232:233], v222
    ds_add_f64 v36, v[232:233] offset:512
    v_mfma_f32_32x32x16_bf16 v[56:71], v[92:95], v[160:163], v[56:71]
    s_add_u32 m0, s36, 1024
    s_nop 0
    buffer_load_dwordx4 v[18:19], s[4:7], 0 idxen offen lds
    v_exp_f32 v40, v72
    v_exp_f32 v41, v73
    v_exp_f32 v42, v74
    ds_read_b128 v[124:127], v11 offset:10752
    v_mfma_f32_32x32x16_bf16 v[56:71], v[96:99], v[176:179], v[56:71]
    s_add_u32 m0, s36, 2048
    s_nop 0
    buffer_load_dwordx4 v[20:21], s[4:7], 0 idxen offen lds
    v_exp_f32 v43, v75
    v_exp_f32 v44, v76
    v_exp_f32 v45, v77
    v_cmp_ne_u32 vcc, v32, v35
    v_mfma_f32_32x32x16_bf16 v[56:71], v[100:103], v[192:195], v[56:71]
    s_add_u32 m0, s36, 3072
    s_nop 0
    buffer_load_dwordx4 v[22:23], s[4:7], 0 idxen offen lds
    v_exp_f32 v46, v78
    v_exp_f32 v47, v79
    v_exp_f32 v48, v80
    s_cmp_eq_u64 vcc, 0
    s_cselect_b32 s29, 1, 0
    s_waitcnt vmcnt(4)
    v_mfma_f32_32x32x16_bf16 v[56:71], v[104:107], v[128:131], v[56:71]
    buffer_load_dwordx4 v[248:251], v[24:25], s[8:11], 0 idxen offen
    v_exp_f32 v49, v81
    v_exp_f32 v50, v82
    v_exp_f32 v51, v83
    v_mfma_f32_32x32x16_bf16 v[56:71], v[108:111], v[112:115], v[56:71]
    v_exp_f32 v52, v84
    v_exp_f32 v53, v85
    v_exp_f32 v54, v86
    v_exp_f32 v55, v87
    v_pk_fma_f32 v[72:73], v[72:73], v[42:43], v[72:73]
    v_pk_fma_f32 v[80:81], v[80:81], v[50:51], v[80:81]
    v_pk_add_f32 v[40:41], v[40:41], 1.0 op_sel_hi:[1,0]
    v_pk_add_f32 v[48:49], v[48:49], 1.0 op_sel_hi:[1,0]
    v_pk_fma_f32 v[72:73], v[74:75], v[40:41], v[72:73]
    v_pk_fma_f32 v[80:81], v[82:83], v[48:49], v[80:81]
    v_pk_fma_f32 v[40:41], v[40:41], v[42:43], v[40:41]
    v_pk_fma_f32 v[48:49], v[48:49], v[50:51], v[48:49]
    v_pk_fma_f32 v[72:73], v[72:73], v[44:45], v[72:73]
    v_pk_fma_f32 v[80:81], v[80:81], v[52:53], v[80:81]
    v_pk_fma_f32 v[72:73], v[76:77], v[40:41], v[72:73]
    v_pk_fma_f32 v[80:81], v[84:85], v[48:49], v[80:81]
    v_pk_fma_f32 v[40:41], v[40:41], v[44:45], v[40:41]
    v_pk_fma_f32 v[48:49], v[48:49], v[52:53], v[48:49]
    v_pk_fma_f32 v[72:73], v[72:73], v[46:47], v[72:73]
    v_pk_fma_f32 v[80:81], v[80:81], v[54:55], v[80:81]
    v_pk_fma_f32 v[228:229], v[78:79], v[40:41], v[72:73]
    v_pk_fma_f32 v[230:231], v[86:87], v[48:49], v[80:81]
    v_pk_fma_f32 v[224:225], v[40:41], v[46:47], v[40:41]
    v_pk_fma_f32 v[226:227], v[48:49], v[54:55], v[48:49]
    v_pk_mul_f32 v[236:237], v[228:229], v[226:227]
    v_pk_fma_f32 v[228:229], v[230:231], v[224:225], v[236:237]
    v_pk_mul_f32 v[224:225], v[224:225], v[226:227]
    v_add_u32 v1, 512, v1
    v_add_u32 v2, 512, v2
    v_add_u32 v3, 512, v3
    v_add_u32 v4, 64, v4
    v_add_u32 v5, 64, v5
    s_sub_u32 s37, s37, 1
    s_cmp_eq_u32 s37, 1
    s_cbranch_scc0 B_W2T111
    s_mov_b32 s16, s60
    s_and_b32 s17, s61, 0xffff
    s_mov_b32 s18, 16384
    s_mov_b32 s19, 0x20000
    v_lshlrev_b32 v247, 4, v211
    s_lshl_b32 s24, s32, 11
    s_add_u32 m0, s24, 140544
    s_add_u32 s25, s24, 0
    buffer_load_dwordx4 v247, s[16:19], s25 offen lds
    s_add_u32 m0, s24, 141568
    s_add_u32 s25, s24, 1024
    buffer_load_dwordx4 v247, s[16:19], s25 offen lds
    s_mov_b32 s16, s62
    s_and_b32 s17, s63, 0xffff
    s_mov_b32 s18, 128
    s_mov_b32 s19, 0x20000
    s_mov_b32 m0, 156928
    s_nop 0
    buffer_load_dwordx4 v247, s[16:19], 0 offen lds
B_W2T111:
    s_cmp_eq_u32 s37, 2
    s_cbranch_scc0 B_PT1112
    s_setprio 1
B_PT1112:
    s_cmp_eq_u32 s37, 1
    s_cbranch_scc0 B_PT1111
    s_setprio 0
B_PT1111:
    s_cmp_eq_u32 s37, 0
    s_cbranch_scc1 B_DRAIN11
    s_cmp_eq_u32 s29, 0
    s_cbranch_scc1 B_T010
B_T011:
    v_mfma_f32_32x32x16_bf16 v[72:87], v[88:91], v[148:151], 0
    v_mul_f32 v226, v224, v225
    v_mul_f32 v230, v228, v225
    v_fma_f32 v230, v229, v224, v230
    v_rcp_f32 v227, v226
    v_add_f32 v28, v28, v226
    v_mul_f32 v230, v230, v227
    v_cvt_f64_f32 v[232:233], v230
    ds_add_f64 v36, v[232:233] offset:768
    v_mfma_f32_32x32x16_bf16 v[72:87], v[92:95], v[164:167], v[72:87]
    v_exp_f32 v40, v56
    v_exp_f32 v41, v57
    v_exp_f32 v42, v58
    ds_read_b32 v26, v5 offset:32
    ds_read_u16 v15, v3 offset:256
    v_mfma_f32_32x32x16_bf16 v[72:87], v[96:99], v[180:183], v[72:87]
    v_exp_f32 v43, v59
    v_exp_f32 v44, v60
    v_exp_f32 v45, v61
    v_add_u32 v32, v32, v14
    v_mfma_f32_32x32x16_bf16 v[72:87], v[100:103], v[196:199], v[72:87]
    v_exp_f32 v46, v62
    v_exp_f32 v47, v63
    v_exp_f32 v48, v64
    v_mfma_f32_32x32x16_bf16 v[72:87], v[104:107], v[132:135], v[72:87]
    v_exp_f32 v49, v65
    v_exp_f32 v50, v66
    v_exp_f32 v51, v67
    v_mfma_f32_32x32x16_bf16 v[72:87], v[108:111], v[116:119], v[72:87]
    v_exp_f32 v52, v68
    v_exp_f32 v53, v69
    v_exp_f32 v54, v70
    v_exp_f32 v55, v71
    v_pk_fma_f32 v[56:57], v[56:57], v[42:43], v[56:57]
    v_pk_fma_f32 v[64:65], v[64:65], v[50:51], v[64:65]
    v_pk_add_f32 v[40:41], v[40:41], 1.0 op_sel_hi:[1,0]
    v_pk_add_f32 v[48:49], v[48:49], 1.0 op_sel_hi:[1,0]
    v_pk_fma_f32 v[56:57], v[58:59], v[40:41], v[56:57]
    v_pk_fma_f32 v[64:65], v[66:67], v[48:49], v[64:65]
    v_pk_fma_f32 v[40:41], v[40:41], v[42:43], v[40:41]
    v_pk_fma_f32 v[48:49], v[48:49], v[50:51], v[48:49]
    v_pk_fma_f32 v[56:57], v[56:57], v[44:45], v[56:57]
    v_pk_fma_f32 v[64:65], v[64:65], v[52:53], v[64:65]
    v_pk_fma_f32 v[56:57], v[60:61], v[40:41], v[56:57]
    v_pk_fma_f32 v[64:65], v[68:69], v[48:49], v[64:65]
    v_pk_fma_f32 v[40:41], v[40:41], v[44:45], v[40:41]
    v_pk_fma_f32 v[48:49], v[48:49], v[52:53], v[48:49]
    v_pk_fma_f32 v[56:57], v[56:57], v[46:47], v[56:57]
    v_pk_fma_f32 v[64:65], v[64:65], v[54:55], v[64:65]
    v_pk_fma_f32 v[220:221], v[62:63], v[40:41], v[56:57]
    v_pk_fma_f32 v[222:223], v[70:71], v[48:49], v[64:65]
    v_pk_fma_f32 v[216:217], v[40:41], v[46:47], v[40:41]
    v_pk_fma_f32 v[218:219], v[48:49], v[54:55], v[48:49]
    v_pk_mul_f32 v[236:237], v[220:221], v[218:219]
    v_pk_fma_f32 v[220:221], v[222:223], v[216:217], v[236:237]
    v_pk_mul_f32 v[216:217], v[216:217], v[218:219]
    s_waitcnt lgkmcnt(0)
    v_mfma_f32_32x32x16_bf16 v[56:71], v[88:91], v[152:155], 0
    v_mul_f32 v218, v216, v217
    v_mul_f32 v222, v220, v217
    v_fma_f32 v222, v221, v216, v222
    v_rcp_f32 v219, v218
    v_add_f32 v28, v28, v218
    v_mul_f32 v222, v222, v219
    v_cvt_f64_f32 v[232:233], v222
    ds_add_f64 v32, v[232:233] offset:0
    v_mfma_f32_32x32x16_bf16 v[56:71], v[92:95], v[168:171], v[56:71]
    v_exp_f32 v40, v72
    v_exp_f32 v41, v73
    v_exp_f32 v42, v74
    v_add_u32 v27, v26, v13
    v_lshrrev_b32 v27, 14, v27
    v_lshl_add_u32 v11, v27, 5, v12
    v_add_u32 v15, v15, v241
    ds_read_b128 v[112:115], v11 offset:0
    ds_read_b128 v[116:119], v11 offset:3584
    v_mfma_f32_32x32x16_bf16 v[56:71], v[96:99], v[184:187], v[56:71]
    v_exp_f32 v43, v75
    v_exp_f32 v44, v76
    v_exp_f32 v45, v77
    ds_read_u16 v16, v1 offset:512
    ds_read_u16 v18, v1 offset:528
    ds_read_u16 v20, v1 offset:576
    ds_read_u16 v22, v1 offset:592
    ds_read_b32 v24, v2 offset:512
    v_mfma_f32_32x32x16_bf16 v[56:71], v[100:103], v[200:203], v[56:71]
    v_exp_f32 v46, v78
    v_exp_f32 v47, v79
    v_exp_f32 v48, v80
    v_mfma_f32_32x32x16_bf16 v[56:71], v[104:107], v[136:139], v[56:71]
    v_exp_f32 v49, v81
    v_exp_f32 v50, v82
    v_exp_f32 v51, v83
    v_mfma_f32_32x32x16_bf16 v[56:71], v[108:111], v[120:123], v[56:71]
    v_exp_f32 v52, v84
    v_exp_f32 v53, v85
    v_exp_f32 v54, v86
    v_exp_f32 v55, v87
    v_pk_fma_f32 v[72:73], v[72:73], v[42:43], v[72:73]
    v_pk_fma_f32 v[80:81], v[80:81], v[50:51], v[80:81]
    v_pk_add_f32 v[40:41], v[40:41], 1.0 op_sel_hi:[1,0]
    v_pk_add_f32 v[48:49], v[48:49], 1.0 op_sel_hi:[1,0]
    v_pk_fma_f32 v[72:73], v[74:75], v[40:41], v[72:73]
    v_pk_fma_f32 v[80:81], v[82:83], v[48:49], v[80:81]
    v_pk_fma_f32 v[40:41], v[40:41], v[42:43], v[40:41]
    v_pk_fma_f32 v[48:49], v[48:49], v[50:51], v[48:49]
    v_pk_fma_f32 v[72:73], v[72:73], v[44:45], v[72:73]
    v_pk_fma_f32 v[80:81], v[80:81], v[52:53], v[80:81]
    v_pk_fma_f32 v[72:73], v[76:77], v[40:41], v[72:73]
    v_pk_fma_f32 v[80:81], v[84:85], v[48:49], v[80:81]
    v_pk_fma_f32 v[40:41], v[40:41], v[44:45], v[40:41]
    v_pk_fma_f32 v[48:49], v[48:49], v[52:53], v[48:49]
    v_pk_fma_f32 v[72:73], v[72:73], v[46:47], v[72:73]
    v_pk_fma_f32 v[80:81], v[80:81], v[54:55], v[80:81]
    v_pk_fma_f32 v[228:229], v[78:79], v[40:41], v[72:73]
    v_pk_fma_f32 v[230:231], v[86:87], v[48:49], v[80:81]
    v_pk_fma_f32 v[224:225], v[40:41], v[46:47], v[40:41]
    v_pk_fma_f32 v[226:227], v[48:49], v[54:55], v[48:49]
    v_pk_mul_f32 v[236:237], v[228:229], v[226:227]
    v_pk_fma_f32 v[228:229], v[230:231], v[224:225], v[236:237]
    v_pk_mul_f32 v[224:225], v[224:225], v[226:227]
    v_mfma_f32_32x32x16_bf16 v[72:87], v[88:91], v[156:159], 0
    v_mul_f32 v226, v224, v225
    v_mul_f32 v230, v228, v225
    v_fma_f32 v230, v229, v224, v230
    v_rcp_f32 v227, v226
    v_add_f32 v28, v28, v226
    v_mul_f32 v230, v230, v227
    v_cvt_f64_f32 v[232:233], v230
    ds_add_f64 v32, v[232:233] offset:256
    v_mfma_f32_32x32x16_bf16 v[72:87], v[92:95], v[172:175], v[72:87]
    v_exp_f32 v40, v56
    v_exp_f32 v41, v57
    v_exp_f32 v42, v58
    ds_read_b128 v[120:123], v11 offset:7168
    ds_read_b128 v[36:39], v4 offset:32
    v_mfma_f32_32x32x16_bf16 v[72:87], v[96:99], v[188:191], v[72:87]
    v_exp_f32 v43, v59
    v_exp_f32 v44, v60
    v_exp_f32 v45, v61
    v_mfma_f32_32x32x16_bf16 v[72:87], v[100:103], v[204:207], v[72:87]
    v_exp_f32 v46, v62
    v_exp_f32 v47, v63
    v_exp_f32 v48, v64
    v_mfma_f32_32x32x16_bf16 v[72:87], v[104:107], v[140:143], v[72:87]
    v_exp_f32 v49, v65
    v_exp_f32 v50, v66
    v_exp_f32 v51, v67
    v_mfma_f32_32x32x16_bf16 v[72:87], v[108:111], v[124:127], v[72:87]
    s_waitcnt vmcnt(1)
    ds_read_b128 v[88:91], v6
    ds_read_b128 v[92:95], v7
    ds_read_b128 v[96:99], v8
    ds_read_b128 v[100:103], v9
    ds_read_b128 v[108:111], v15 offset:1
    v_exp_f32 v52, v68
    v_exp_f32 v53, v69
    v_exp_f32 v54, v70
    v_exp_f32 v55, v71
    v_pk_fma_f32 v[56:57], v[56:57], v[42:43], v[56:57]
    v_pk_fma_f32 v[64:65], v[64:65], v[50:51], v[64:65]
    v_pk_add_f32 v[40:41], v[40:41], 1.0 op_sel_hi:[1,0]
    v_pk_add_f32 v[48:49], v[48:49], 1.0 op_sel_hi:[1,0]
    v_pk_fma_f32 v[56:57], v[58:59], v[40:41], v[56:57]
    v_pk_fma_f32 v[64:65], v[66:67], v[48:49], v[64:65]
    v_pk_fma_f32 v[40:41], v[40:41], v[42:43], v[40:41]
    v_pk_fma_f32 v[48:49], v[48:49], v[50:51], v[48:49]
    v_pk_fma_f32 v[56:57], v[56:57], v[44:45], v[56:57]
    v_pk_fma_f32 v[64:65], v[64:65], v[52:53], v[64:65]
    v_pk_fma_f32 v[56:57], v[60:61], v[40:41], v[56:57]
    v_pk_fma_f32 v[64:65], v[68:69], v[48:49], v[64:65]
    v_pk_fma_f32 v[40:41], v[40:41], v[44:45], v[40:41]
    v_pk_fma_f32 v[48:49], v[48:49], v[52:53], v[48:49]
    v_pk_fma_f32 v[56:57], v[56:57], v[46:47], v[56:57]
    v_pk_fma_f32 v[64:65], v[64:65], v[54:55], v[64:65]
    v_pk_fma_f32 v[220:221], v[62:63], v[40:41], v[56:57]
    v_pk_fma_f32 v[222:223], v[70:71], v[48:49], v[64:65]
    v_pk_fma_f32 v[216:217], v[40:41], v[46:47], v[40:41]
    v_pk_fma_f32 v[218:219], v[48:49], v[54:55], v[48:49]
    v_pk_mul_f32 v[236:237], v[220:221], v[218:219]
    v_pk_fma_f32 v[220:221], v[222:223], v[216:217], v[236:237]
    v_pk_mul_f32 v[216:217], v[216:217], v[218:219]
    s_waitcnt lgkmcnt(0)
    s_cmp_ge_u32 s37, 3
    s_cselect_b32 s6, 10000, 0
    s_cselect_b32 s10, 640000, 0
    v_mfma_f32_32x32x16_bf16 v[56:71], v[88:91], v[144:147], 0
    s_add_u32 m0, s36, 0
    s_nop 0
    buffer_load_dwordx4 v[16:17], s[4:7], 0 idxen offen lds
    v_mul_f32 v218, v216, v217
    v_mul_f32 v222, v220, v217
    v_fma_f32 v222, v221, v216, v222
    v_rcp_f32 v219, v218
    v_add_f32 v28, v28, v218
    v_mul_f32 v222, v222, v219
    v_cvt_f64_f32 v[232:233], v222
    ds_add_f64 v32, v[232:233] offset:512
    v_mfma_f32_32x32x16_bf16 v[56:71], v[92:95], v[160:163], v[56:71]
    s_add_u32 m0, s36, 1024
    s_nop 0
    buffer_load_dwordx4 v[18:19], s[4:7], 0 idxen offen lds
    v_exp_f32 v40, v72
    v_exp_f32 v41, v73
    v_exp_f32 v42, v74
    ds_read_b128 v[124:127], v11 offset:10752
    v_mfma_f32_32x32x16_bf16 v[56:71], v[96:99], v[176:179], v[56:71]
    s_add_u32 m0, s36, 2048
    s_nop 0
    buffer_load_dwordx4 v[20:21], s[4:7], 0 idxen offen lds
    v_exp_f32 v43, v75
    v_exp_f32 v44, v76
    v_exp_f32 v45, v77
    v_cmp_ne_u32 vcc, v36, v39
    v_mfma_f32_32x32x16_bf16 v[56:71], v[100:103], v[192:195], v[56:71]
    s_add_u32 m0, s36, 3072
    s_nop 0
    buffer_load_dwordx4 v[22:23], s[4:7], 0 idxen offen lds
    v_exp_f32 v46, v78
    v_exp_f32 v47, v79
    v_exp_f32 v48, v80
    s_cmp_eq_u64 vcc, 0
    s_cselect_b32 s29, 1, 0
    s_waitcnt vmcnt(4)
    v_mfma_f32_32x32x16_bf16 v[56:71], v[248:251], v[128:131], v[56:71]
    buffer_load_dwordx4 v[104:107], v[24:25], s[8:11], 0 idxen offen
    v_exp_f32 v49, v81
    v_exp_f32 v50, v82
    v_exp_f32 v51, v83
    v_mfma_f32_32x32x16_bf16 v[56:71], v[108:111], v[112:115], v[56:71]
    v_exp_f32 v52, v84
    v_exp_f32 v53, v85
    v_exp_f32 v54, v86
    v_exp_f32 v55, v87
    v_pk_fma_f32 v[72:73], v[72:73], v[42:43], v[72:73]
    v_pk_fma_f32 v[80:81], v[80:81], v[50:51], v[80:81]
    v_pk_add_f32 v[40:41], v[40:41], 1.0 op_sel_hi:[1,0]
    v_pk_add_f32 v[48:49], v[48:49], 1.0 op_sel_hi:[1,0]
    v_pk_fma_f32 v[72:73], v[74:75], v[40:41], v[72:73]
    v_pk_fma_f32 v[80:81], v[82:83], v[48:49], v[80:81]
    v_pk_fma_f32 v[40:41], v[40:41], v[42:43], v[40:41]
    v_pk_fma_f32 v[48:49], v[48:49], v[50:51], v[48:49]
    v_pk_fma_f32 v[72:73], v[72:73], v[44:45], v[72:73]
    v_pk_fma_f32 v[80:81], v[80:81], v[52:53], v[80:81]
    v_pk_fma_f32 v[72:73], v[76:77], v[40:41], v[72:73]
    v_pk_fma_f32 v[80:81], v[84:85], v[48:49], v[80:81]
    v_pk_fma_f32 v[40:41], v[40:41], v[44:45], v[40:41]
    v_pk_fma_f32 v[48:49], v[48:49], v[52:53], v[48:49]
    v_pk_fma_f32 v[72:73], v[72:73], v[46:47], v[72:73]
    v_pk_fma_f32 v[80:81], v[80:81], v[54:55], v[80:81]
    v_pk_fma_f32 v[228:229], v[78:79], v[40:41], v[72:73]
    v_pk_fma_f32 v[230:231], v[86:87], v[48:49], v[80:81]
    v_pk_fma_f32 v[224:225], v[40:41], v[46:47], v[40:41]
    v_pk_fma_f32 v[226:227], v[48:49], v[54:55], v[48:49]
    v_pk_mul_f32 v[236:237], v[228:229], v[226:227]
    v_pk_fma_f32 v[228:229], v[230:231], v[224:225], v[236:237]
    v_pk_mul_f32 v[224:225], v[224:225], v[226:227]
    s_sub_u32 s37, s37, 1
    s_cmp_eq_u32 s37, 1
    s_cbranch_scc0 B_W2T011
    s_mov_b32 s16, s60
    s_and_b32 s17, s61, 0xffff
    s_mov_b32 s18, 16384
    s_mov_b32 s19, 0x20000
    v_lshlrev_b32 v247, 4, v211
    s_lshl_b32 s24, s32, 11
    s_add_u32 m0, s24, 140544
    s_add_u32 s25, s24, 0
    buffer_load_dwordx4 v247, s[16:19], s25 offen lds
    s_add_u32 m0, s24, 141568
    s_add_u32 s25, s24, 1024
    buffer_load_dwordx4 v247, s[16:19], s25 offen lds
    s_mov_b32 s16, s62
    s_and_b32 s17, s63, 0xffff
    s_mov_b32 s18, 128
    s_mov_b32 s19, 0x20000
    s_mov_b32 m0, 156928
    s_nop 0
    buffer_load_dwordx4 v247, s[16:19], 0 offen lds
B_W2T011:
    s_cmp_eq_u32 s37, 2
    s_cbranch_scc0 B_PT0112
    s_setprio 1
B_PT0112:
    s_cmp_eq_u32 s37, 1
    s_cbranch_scc0 B_PT0111
    s_setprio 0
B_PT0111:
    s_cmp_eq_u32 s37, 0
    s_cbranch_scc1 B_DRAIN01
    s_cmp_eq_u32 s29, 0
    s_cbranch_scc0 B_T111
B_T110:
    v_mfma_f32_32x32x16_bf16 v[72:87], v[88:91], v[148:151], 0
    v_mul_f32 v226, v224, v225
    v_mul_f32 v230, v228, v225
    v_fma_f32 v230, v229, v224, v230
    v_rcp_f32 v227, v226
    v_add_f32 v28, v28, v226
    v_mul_f32 v230, v230, v227
    v_cvt_f64_f32 v[232:233], v230
    ds_add_f64 v32, v[232:233] offset:768
    v_mfma_f32_32x32x16_bf16 v[72:87], v[92:95], v[164:167], v[72:87]
    v_exp_f32 v40, v56
    v_exp_f32 v41, v57
    v_exp_f32 v42, v58
    ds_read_b32 v26, v5 offset:64
    ds_read_u16 v15, v3 offset:512
    v_mfma_f32_32x32x16_bf16 v[72:87], v[96:99], v[180:183], v[72:87]
    v_exp_f32 v43, v59
    v_exp_f32 v44, v60
    v_exp_f32 v45, v61
    v_add_u32 v36, v36, v14
    v_add_u32 v37, v37, v14
    v_add_u32 v38, v38, v14
    v_add_u32 v39, v39, v14
    v_mfma_f32_32x32x16_bf16 v[72:87], v[100:103], v[196:199], v[72:87]
    v_exp_f32 v46, v62
    v_exp_f32 v47, v63
    v_exp_f32 v48, v64
    v_mfma_f32_32x32x16_bf16 v[72:87], v[248:251], v[132:135], v[72:87]
    v_exp_f32 v49, v65
    v_exp_f32 v50, v66
    v_exp_f32 v51, v67
    v_mfma_f32_32x32x16_bf16 v[72:87], v[108:111], v[116:119], v[72:87]
    v_exp_f32 v52, v68
    v_exp_f32 v53, v69
    v_exp_f32 v54, v70
    v_exp_f32 v55, v71
    v_pk_fma_f32 v[56:57], v[56:57], v[42:43], v[56:57]
    v_pk_fma_f32 v[64:65], v[64:65], v[50:51], v[64:65]
    v_pk_add_f32 v[40:41], v[40:41], 1.0 op_sel_hi:[1,0]
    v_pk_add_f32 v[48:49], v[48:49], 1.0 op_sel_hi:[1,0]
    v_pk_fma_f32 v[56:57], v[58:59], v[40:41], v[56:57]
    v_pk_fma_f32 v[64:65], v[66:67], v[48:49], v[64:65]
    v_pk_fma_f32 v[40:41], v[40:41], v[42:43], v[40:41]
    v_pk_fma_f32 v[48:49], v[48:49], v[50:51], v[48:49]
    v_pk_fma_f32 v[56:57], v[56:57], v[44:45], v[56:57]
    v_pk_fma_f32 v[64:65], v[64:65], v[52:53], v[64:65]
    v_pk_fma_f32 v[56:57], v[60:61], v[40:41], v[56:57]
    v_pk_fma_f32 v[64:65], v[68:69], v[48:49], v[64:65]
    v_pk_fma_f32 v[40:41], v[40:41], v[44:45], v[40:41]
    v_pk_fma_f32 v[48:49], v[48:49], v[52:53], v[48:49]
    v_pk_fma_f32 v[56:57], v[56:57], v[46:47], v[56:57]
    v_pk_fma_f32 v[64:65], v[64:65], v[54:55], v[64:65]
    v_pk_fma_f32 v[220:221], v[62:63], v[40:41], v[56:57]
    v_pk_fma_f32 v[222:223], v[70:71], v[48:49], v[64:65]
    v_pk_fma_f32 v[216:217], v[40:41], v[46:47], v[40:41]
    v_pk_fma_f32 v[218:219], v[48:49], v[54:55], v[48:49]
    v_pk_fma_f32 v[28:29], v[216:217], v[218:219], v[28:29]
    s_waitcnt lgkmcnt(0)
    v_mfma_f32_32x32x16_bf16 v[56:71], v[88:91], v[152:155], 0
    v_rcp_f32 v216, v216
    v_rcp_f32 v217, v217
    v_rcp_f32 v218, v218
    v_rcp_f32 v219, v219
    v_mfma_f32_32x32x16_bf16 v[56:71], v[92:95], v[168:171], v[56:71]
    v_exp_f32 v40, v72
    v_exp_f32 v41, v73
    v_exp_f32 v42, v74
    v_add_u32 v27, v26, v13
    v_lshrrev_b32 v27, 14, v27
    v_lshl_add_u32 v11, v27, 5, v12
    v_add_u32 v15, v15, v241
    ds_read_b128 v[112:115], v11 offset:0
    ds_read_b128 v[116:119], v11 offset:3584
    v_mfma_f32_32x32x16_bf16 v[56:71], v[96:99], v[184:187], v[56:71]
    v_exp_f32 v43, v75
    v_exp_f32 v44, v76
    v_exp_f32 v45, v77
    ds_read_u16 v16, v1 offset:768
    ds_read_u16 v18, v1 offset:784
    ds_read_u16 v20, v1 offset:832
    ds_read_u16 v22, v1 offset:848
    ds_read_b32 v24, v2 offset:768
    v_mfma_f32_32x32x16_bf16 v[56:71], v[100:103], v[200:203], v[56:71]
    v_exp_f32 v46, v78
    v_exp_f32 v47, v79
    v_exp_f32 v48, v80
    v_mfma_f32_32x32x16_bf16 v[56:71], v[248:251], v[136:139], v[56:71]
    v_exp_f32 v49, v81
    v_exp_f32 v50, v82
    v_exp_f32 v51, v83
    v_mfma_f32_32x32x16_bf16 v[56:71], v[108:111], v[120:123], v[56:71]
    v_exp_f32 v52, v84
    v_exp_f32 v53, v85
    v_exp_f32 v54, v86
    v_exp_f32 v55, v87
    v_pk_mul_f32 v[220:221], v[220:221], v[216:217]
    v_pk_mul_f32 v[222:223], v[222:223], v[218:219]
    v_pk_fma_f32 v[72:73], v[72:73], v[42:43], v[72:73]
    v_pk_fma_f32 v[80:81], v[80:81], v[50:51], v[80:81]
    v_pk_add_f32 v[40:41], v[40:41], 1.0 op_sel_hi:[1,0]
    v_pk_add_f32 v[48:49], v[48:49], 1.0 op_sel_hi:[1,0]
    v_pk_fma_f32 v[72:73], v[74:75], v[40:41], v[72:73]
    v_pk_fma_f32 v[80:81], v[82:83], v[48:49], v[80:81]
    v_pk_fma_f32 v[40:41], v[40:41], v[42:43], v[40:41]
    v_pk_fma_f32 v[48:49], v[48:49], v[50:51], v[48:49]
    v_pk_fma_f32 v[72:73], v[72:73], v[44:45], v[72:73]
    v_pk_fma_f32 v[80:81], v[80:81], v[52:53], v[80:81]
    v_pk_fma_f32 v[72:73], v[76:77], v[40:41], v[72:73]
    v_pk_fma_f32 v[80:81], v[84:85], v[48:49], v[80:81]
    v_pk_fma_f32 v[40:41], v[40:41], v[44:45], v[40:41]
    v_pk_fma_f32 v[48:49], v[48:49], v[52:53], v[48:49]
    v_pk_fma_f32 v[72:73], v[72:73], v[46:47], v[72:73]
    v_pk_fma_f32 v[80:81], v[80:81], v[54:55], v[80:81]
    v_pk_fma_f32 v[228:229], v[78:79], v[40:41], v[72:73]
    v_pk_fma_f32 v[230:231], v[86:87], v[48:49], v[80:81]
    v_pk_fma_f32 v[224:225], v[40:41], v[46:47], v[40:41]
    v_pk_fma_f32 v[226:227], v[48:49], v[54:55], v[48:49]
    v_pk_fma_f32 v[28:29], v[224:225], v[226:227], v[28:29]
    v_mfma_f32_32x32x16_bf16 v[72:87], v[88:91], v[156:159], 0
    v_rcp_f32 v224, v224
    v_rcp_f32 v225, v225
    v_rcp_f32 v226, v226
    v_rcp_f32 v227, v227
    v_mfma_f32_32x32x16_bf16 v[72:87], v[92:95], v[172:175], v[72:87]
    v_exp_f32 v40, v56
    v_exp_f32 v41, v57
    v_exp_f32 v42, v58
    ds_read_b128 v[120:123], v11 offset:7168
    ds_read_b128 v[32:35], v4 offset:64
    v_mfma_f32_32x32x16_bf16 v[72:87], v[96:99], v[188:191], v[72:87]
    v_exp_f32 v43, v59
    v_exp_f32 v44, v60
    v_exp_f32 v45, v61
    v_mfma_f32_32x32x16_bf16 v[72:87], v[100:103], v[204:207], v[72:87]
    v_exp_f32 v46, v62
    v_exp_f32 v47, v63
    v_exp_f32 v48, v64
    v_mfma_f32_32x32x16_bf16 v[72:87], v[248:251], v[140:143], v[72:87]
    v_exp_f32 v49, v65
    v_exp_f32 v50, v66
    v_exp_f32 v51, v67
    v_mfma_f32_32x32x16_bf16 v[72:87], v[108:111], v[124:127], v[72:87]
    s_waitcnt vmcnt(1)
    ds_read_b128 v[88:91], v6
    ds_read_b128 v[92:95], v7
    ds_read_b128 v[96:99], v8
    ds_read_b128 v[100:103], v9
    ds_read_b128 v[108:111], v15 offset:1
    v_exp_f32 v52, v68
    v_exp_f32 v53, v69
    v_exp_f32 v54, v70
    v_exp_f32 v55, v71
    v_cvt_f64_f32 v[232:233], v220
    v_cvt_f64_f32 v[234:235], v221
    v_cvt_f64_f32 v[236:237], v222
    v_cvt_f64_f32 v[238:239], v223
    ds_add_f64 v36, v[232:233] offset:0
    ds_add_f64 v37, v[234:235] offset:0
    ds_add_f64 v38, v[236:237] offset:0
    ds_add_f64 v39, v[238:239] offset:0
    v_pk_mul_f32 v[228:229], v[228:229], v[224:225]
    v_pk_mul_f32 v[230:231], v[230:231], v[226:227]
    v_pk_fma_f32 v[56:57], v[56:57], v[42:43], v[56:57]
    v_pk_fma_f32 v[64:65], v[64:65], v[50:51], v[64:65]
    v_pk_add_f32 v[40:41], v[40:41], 1.0 op_sel_hi:[1,0]
    v_pk_add_f32 v[48:49], v[48:49], 1.0 op_sel_hi:[1,0]
    v_pk_fma_f32 v[56:57], v[58:59], v[40:41], v[56:57]
    v_pk_fma_f32 v[64:65], v[66:67], v[48:49], v[64:65]
    v_pk_fma_f32 v[40:41], v[40:41], v[42:43], v[40:41]
    v_pk_fma_f32 v[48:49], v[48:49], v[50:51], v[48:49]
    v_pk_fma_f32 v[56:57], v[56:57], v[44:45], v[56:57]
    v_pk_fma_f32 v[64:65], v[64:65], v[52:53], v[64:65]
    v_pk_fma_f32 v[56:57], v[60:61], v[40:41], v[56:57]
    v_pk_fma_f32 v[64:65], v[68:69], v[48:49], v[64:65]
    v_pk_fma_f32 v[40:41], v[40:41], v[44:45], v[40:41]
    v_pk_fma_f32 v[48:49], v[48:49], v[52:53], v[48:49]
    v_pk_fma_f32 v[56:57], v[56:57], v[46:47], v[56:57]
    v_pk_fma_f32 v[64:65], v[64:65], v[54:55], v[64:65]
    v_pk_fma_f32 v[220:221], v[62:63], v[40:41], v[56:57]
    v_pk_fma_f32 v[222:223], v[70:71], v[48:49], v[64:65]
    v_pk_fma_f32 v[216:217], v[40:41], v[46:47], v[40:41]
    v_pk_fma_f32 v[218:219], v[48:49], v[54:55], v[48:49]
    v_pk_fma_f32 v[28:29], v[216:217], v[218:219], v[28:29]
    s_waitcnt lgkmcnt(4)
    s_cmp_ge_u32 s37, 3
    s_cselect_b32 s6, 10000, 0
    s_cselect_b32 s10, 640000, 0
    v_mfma_f32_32x32x16_bf16 v[56:71], v[88:91], v[144:147], 0
    s_add_u32 m0, s36, 0
    s_nop 0
    buffer_load_dwordx4 v[16:17], s[4:7], 0 idxen offen lds
    v_rcp_f32 v216, v216
    v_rcp_f32 v217, v217
    v_rcp_f32 v218, v218
    v_rcp_f32 v219, v219
    v_mfma_f32_32x32x16_bf16 v[56:71], v[92:95], v[160:163], v[56:71]
    s_add_u32 m0, s36, 1024
    s_nop 0
    buffer_load_dwordx4 v[18:19], s[4:7], 0 idxen offen lds
    v_exp_f32 v40, v72
    v_exp_f32 v41, v73
    v_exp_f32 v42, v74
    ds_read_b128 v[124:127], v11 offset:10752
    v_mfma_f32_32x32x16_bf16 v[56:71], v[96:99], v[176:179], v[56:71]
    s_add_u32 m0, s36, 2048
    s_nop 0
    buffer_load_dwordx4 v[20:21], s[4:7], 0 idxen offen lds
    v_exp_f32 v43, v75
    v_exp_f32 v44, v76
    v_exp_f32 v45, v77
    v_cmp_ne_u32 vcc, v32, v35
    v_mfma_f32_32x32x16_bf16 v[56:71], v[100:103], v[192:195], v[56:71]
    s_add_u32 m0, s36, 3072
    s_nop 0
    buffer_load_dwordx4 v[22:23], s[4:7], 0 idxen offen lds
    v_exp_f32 v46, v78
    v_exp_f32 v47, v79
    v_exp_f32 v48, v80
    s_cmp_eq_u64 vcc, 0
    s_cselect_b32 s29, 1, 0
    s_waitcnt vmcnt(4)
    v_mfma_f32_32x32x16_bf16 v[56:71], v[104:107], v[128:131], v[56:71]
    buffer_load_dwordx4 v[248:251], v[24:25], s[8:11], 0 idxen offen
    v_exp_f32 v49, v81
    v_exp_f32 v50, v82
    v_exp_f32 v51, v83
    v_mfma_f32_32x32x16_bf16 v[56:71], v[108:111], v[112:115], v[56:71]
    v_exp_f32 v52, v84
    v_exp_f32 v53, v85
    v_exp_f32 v54, v86
    v_exp_f32 v55, v87
    v_cvt_f64_f32 v[232:233], v228
    v_cvt_f64_f32 v[234:235], v229
    v_cvt_f64_f32 v[236:237], v230
    v_cvt_f64_f32 v[238:239], v231
    ds_add_f64 v36, v[232:233] offset:256
    ds_add_f64 v37, v[234:235] offset:256
    ds_add_f64 v38, v[236:237] offset:256
    ds_add_f64 v39, v[238:239] offset:256
    v_pk_mul_f32 v[220:221], v[220:221], v[216:217]
    v_pk_mul_f32 v[222:223], v[222:223], v[218:219]
    v_pk_fma_f32 v[72:73], v[72:73], v[42:43], v[72:73]
    v_pk_fma_f32 v[80:81], v[80:81], v[50:51], v[80:81]
    v_pk_add_f32 v[40:41], v[40:41], 1.0 op_sel_hi:[1,0]
    v_pk_add_f32 v[48:49], v[48:49], 1.0 op_sel_hi:[1,0]
    v_pk_fma_f32 v[72:73], v[74:75], v[40:41], v[72:73]
    v_pk_fma_f32 v[80:81], v[82:83], v[48:49], v[80:81]
    v_pk_fma_f32 v[40:41], v[40:41], v[42:43], v[40:41]
    v_pk_fma_f32 v[48:49], v[48:49], v[50:51], v[48:49]
    v_pk_fma_f32 v[72:73], v[72:73], v[44:45], v[72:73]
    v_pk_fma_f32 v[80:81], v[80:81], v[52:53], v[80:81]
    v_pk_fma_f32 v[72:73], v[76:77], v[40:41], v[72:73]
    v_pk_fma_f32 v[80:81], v[84:85], v[48:49], v[80:81]
    v_pk_fma_f32 v[40:41], v[40:41], v[44:45], v[40:41]
    v_pk_fma_f32 v[48:49], v[48:49], v[52:53], v[48:49]
    v_pk_fma_f32 v[72:73], v[72:73], v[46:47], v[72:73]
    v_pk_fma_f32 v[80:81], v[80:81], v[54:55], v[80:81]
    v_pk_fma_f32 v[228:229], v[78:79], v[40:41], v[72:73]
    v_pk_fma_f32 v[230:231], v[86:87], v[48:49], v[80:81]
    v_pk_fma_f32 v[224:225], v[40:41], v[46:47], v[40:41]
    v_pk_fma_f32 v[226:227], v[48:49], v[54:55], v[48:49]
    v_pk_fma_f32 v[28:29], v[224:225], v[226:227], v[28:29]
    v_add_u32 v1, 512, v1
    v_add_u32 v2, 512, v2
    v_add_u32 v3, 512, v3
    v_add_u32 v4, 64, v4
    v_add_u32 v5, 64, v5
    s_sub_u32 s37, s37, 1
    s_cmp_eq_u32 s37, 1
    s_cbranch_scc0 B_W2T110
    s_mov_b32 s16, s60
    s_and_b32 s17, s61, 0xffff
    s_mov_b32 s18, 16384
    s_mov_b32 s19, 0x20000
    v_lshlrev_b32 v247, 4, v211
    s_lshl_b32 s24, s32, 11
    s_add_u32 m0, s24, 140544
    s_add_u32 s25, s24, 0
    buffer_load_dwordx4 v247, s[16:19], s25 offen lds
    s_add_u32 m0, s24, 141568
    s_add_u32 s25, s24, 1024
    buffer_load_dwordx4 v247, s[16:19], s25 offen lds
    s_mov_b32 s16, s62
    s_and_b32 s17, s63, 0xffff
    s_mov_b32 s18, 128
    s_mov_b32 s19, 0x20000
    s_mov_b32 m0, 156928
    s_nop 0
    buffer_load_dwordx4 v247, s[16:19], 0 offen lds
B_W2T110:
    s_cmp_eq_u32 s37, 2
    s_cbranch_scc0 B_PT1102
    s_setprio 1
B_PT1102:
    s_cmp_eq_u32 s37, 1
    s_cbranch_scc0 B_PT1101
    s_setprio 0
B_PT1101:
    s_cmp_eq_u32 s37, 0
    s_cbranch_scc1 B_DRAIN10
    s_cmp_eq_u32 s29, 0
    s_cbranch_scc0 B_T001
    s_branch B_T000
B_DRAIN00:
    v_rcp_f32 v224, v224
    v_rcp_f32 v225, v225
    v_rcp_f32 v226, v226
    v_rcp_f32 v227, v227
    v_cvt_f64_f32 v[232:233], v220
    v_cvt_f64_f32 v[234:235], v221
    v_cvt_f64_f32 v[236:237], v222
    v_cvt_f64_f32 v[238:239], v223
    ds_add_f64 v32, v[232:233] offset:512
    ds_add_f64 v33, v[234:235] offset:512
    ds_add_f64 v34, v[236:237] offset:512
    ds_add_f64 v35, v[238:239] offset:512
    v_pk_mul_f32 v[228:229], v[228:229], v[224:225]
    v_pk_mul_f32 v[230:231], v[230:231], v[226:227]
    v_cvt_f64_f32 v[232:233], v228
    v_cvt_f64_f32 v[234:235], v229
    v_cvt_f64_f32 v[236:237], v230
    v_cvt_f64_f32 v[238:239], v231
    ds_add_f64 v32, v[232:233] offset:768
    ds_add_f64 v33, v[234:235] offset:768
    ds_add_f64 v34, v[236:237] offset:768
    ds_add_f64 v35, v[238:239] offset:768
    s_branch B_LOOPEND
B_DRAIN01:
    v_mul_f32 v226, v224, v225
    v_mul_f32 v230, v228, v225
    v_fma_f32 v230, v229, v224, v230
    v_rcp_f32 v227, v226
    v_add_f32 v28, v28, v226
    v_mul_f32 v230, v230, v227
    v_cvt_f64_f32 v[232:233], v230
    ds_add_f64 v32, v[232:233] offset:768
    s_branch B_LOOPEND
B_DRAIN10:
    v_rcp_f32 v224, v224
    v_rcp_f32 v225, v225
    v_rcp_f32 v226, v226
    v_rcp_f32 v227, v227
    v_cvt_f64_f32 v[232:233], v220
    v_cvt_f64_f32 v[234:235], v221
    v_cvt_f64_f32 v[236:237], v222
    v_cvt_f64_f32 v[238:239], v223
    ds_add_f64 v36, v[232:233] offset:512
    ds_add_f64 v37, v[234:235] offset:512
    ds_add_f64 v38, v[236:237] offset:512
    ds_add_f64 v39, v[238:239] offset:512
    v_pk_mul_f32 v[228:229], v[228:229], v[224:225]
    v_pk_mul_f32 v[230:231], v[230:231], v[226:227]
    v_cvt_f64_f32 v[232:233], v228
    v_cvt_f64_f32 v[234:235], v229
    v_cvt_f64_f32 v[236:237], v230
    v_cvt_f64_f32 v[238:239], v231
    ds_add_f64 v36, v[232:233] offset:768
    ds_add_f64 v37, v[234:235] offset:768
    ds_add_f64 v38, v[236:237] offset:768
    ds_add_f64 v39, v[238:239] offset:768
    s_branch B_LOOPEND
B_DRAIN11:
    v_mul_f32 v226, v224, v225
    v_mul_f32 v230, v228, v225
    v_fma_f32 v230, v229, v224, v230
    v_rcp_f32 v227, v226
    v_add_f32 v28, v28, v226
    v_mul_f32 v230, v230, v227
    v_cvt_f64_f32 v[232:233], v230
    ds_add_f64 v36, v[232:233] offset:768
    s_branch B_LOOPEND
B_SAFE:
    s_setprio 3
    ds_read_u16 v16, v1 offset:0
    ds_read_u16 v18, v1 offset:16
    ds_read_u16 v20, v1 offset:64
    ds_read_u16 v22, v1 offset:80
    ds_read_b32 v24, v2 offset:0
    ds_read_b128 v[32:35], v4 offset:0
    ds_read_b32 v26, v5 offset:0
    ds_read_u16 v15, v3 offset:0
    s_mul_i32 s24, s3, 256
    s_lshl_b32 s25, s3, 5
    v_add_u32 v1, s24, v1
    v_add_u32 v2, s24, v2
    v_add_u32 v3, s24, v3
    v_add_u32 v4, s25, v4
    v_add_u32 v5, s25, v5
    s_mov_b32 s6, 10000
    s_mov_b32 s10, 640000
    s_waitcnt lgkmcnt(0)
    s_add_u32 m0, s36, 0
    s_nop 0
    buffer_load_dwordx4 v[16:17], s[4:7], 0 idxen offen lds
    s_add_u32 m0, s36, 1024
    s_nop 0
    buffer_load_dwordx4 v[18:19], s[4:7], 0 idxen offen lds
    s_add_u32 m0, s36, 2048
    s_nop 0
    buffer_load_dwordx4 v[20:21], s[4:7], 0 idxen offen lds
    s_add_u32 m0, s36, 3072
    s_nop 0
    buffer_load_dwordx4 v[22:23], s[4:7], 0 idxen offen lds
    buffer_load_dwordx4 v[104:107], v[24:25], s[8:11], 0 idxen offen
    ds_read_b32 v24, v2 offset:256
    v_add_u32 v27, v26, v13
    v_lshrrev_b32 v27, 14, v27
    v_lshl_add_u32 v11, v27, 5, v12
    v_add_u32 v15, v15, v241
    v_add_u32 v32, v32, v14
    v_add_u32 v33, v33, v14
    v_add_u32 v34, v34, v14
    v_add_u32 v35, v35, v14
    ds_read_b128 v[112:115], v11 offset:0
    ds_read_b128 v[116:119], v11 offset:3584
    ds_read_b128 v[120:123], v11 offset:7168
    ds_read_b128 v[124:127], v11 offset:10752
    ds_read_u16 v16, v1 offset:256
    ds_read_u16 v18, v1 offset:272
    ds_read_u16 v20, v1 offset:320
    ds_read_u16 v22, v1 offset:336
    s_waitcnt vmcnt(0)
    ds_read_b128 v[88:91], v6
    ds_read_b128 v[92:95], v7
    ds_read_b128 v[96:99], v8
    ds_read_b128 v[100:103], v9
    ds_read_b128 v[108:111], v15 offset:1
    s_waitcnt lgkmcnt(0)
    s_cmp_ge_u32 s37, 2
    s_cselect_b32 s6, 10000, 0
    s_cselect_b32 s10, 640000, 0
    s_add_u32 m0, s36, 0
    s_nop 0
    buffer_load_dwordx4 v[16:17], s[4:7], 0 idxen offen lds
    s_add_u32 m0, s36, 1024
    s_nop 0
    buffer_load_dwordx4 v[18:19], s[4:7], 0 idxen offen lds
    s_add_u32 m0, s36, 2048
    s_nop 0
    buffer_load_dwordx4 v[20:21], s[4:7], 0 idxen offen lds
    s_add_u32 m0, s36, 3072
    s_nop 0
    buffer_load_dwordx4 v[22:23], s[4:7], 0 idxen offen lds
    buffer_load_dwordx4 v[248:251], v[24:25], s[8:11], 0 idxen offen
    v_mfma_f32_32x32x16_bf16 v[56:71], v[88:91], v[144:147], 0
    v_mfma_f32_32x32x16_bf16 v[56:71], v[92:95], v[160:163], v[56:71]
    v_mfma_f32_32x32x16_bf16 v[56:71], v[96:99], v[176:179], v[56:71]
    v_mfma_f32_32x32x16_bf16 v[56:71], v[100:103], v[192:195], v[56:71]
    v_mfma_f32_32x32x16_bf16 v[56:71], v[104:107], v[128:131], v[56:71]
    v_mfma_f32_32x32x16_bf16 v[56:71], v[108:111], v[112:115], v[56:71]
    s_cmp_le_u32 s37, 1
    s_cbranch_scc0 B_W2PS
    s_mov_b32 s16, s60
    s_and_b32 s17, s61, 0xffff
    s_mov_b32 s18, 16384
    s_mov_b32 s19, 0x20000
    v_lshlrev_b32 v247, 4, v211
    s_lshl_b32 s24, s32, 11
    s_add_u32 m0, s24, 140544
    s_add_u32 s25, s24, 0
    buffer_load_dwordx4 v247, s[16:19], s25 offen lds
    s_add_u32 m0, s24, 141568
    s_add_u32 s25, s24, 1024
    buffer_load_dwordx4 v247, s[16:19], s25 offen lds
    s_mov_b32 s16, s62
    s_and_b32 s17, s63, 0xffff
    s_mov_b32 s18, 128
    s_mov_b32 s19, 0x20000
    s_mov_b32 m0, 156928
    s_nop 0
    buffer_load_dwordx4 v247, s[16:19], 0 offen lds
B_W2PS:
    s_setprio 2
    s_nop 7
    s_nop 3
B_LOOPS:
    ds_read_b128 v[36:39], v4 offset:32
    ds_read_b32 v26, v5 offset:32
    ds_read_u16 v15, v3 offset:256
    v_mfma_f32_32x32x16_bf16 v[72:87], v[88:91], v[148:151], 0
    v_mfma_f32_32x32x16_bf16 v[72:87], v[92:95], v[164:167], v[72:87]
    v_mfma_f32_32x32x16_bf16 v[72:87], v[96:99], v[180:183], v[72:87]
    v_mfma_f32_32x32x16_bf16 v[72:87], v[100:103], v[196:199], v[72:87]
    v_mfma_f32_32x32x16_bf16 v[72:87], v[104:107], v[132:135], v[72:87]
    v_mfma_f32_32x32x16_bf16 v[72:87], v[108:111], v[116:119], v[72:87]
    v_exp_f32 v40, v56
    v_exp_f32 v41, v57
    v_exp_f32 v42, v58
    v_exp_f32 v43, v59
    v_exp_f32 v44, v60
    v_exp_f32 v45, v61
    v_exp_f32 v46, v62
    v_exp_f32 v47, v63
    v_exp_f32 v48, v64
    v_exp_f32 v49, v65
    v_exp_f32 v50, v66
    v_exp_f32 v51, v67
    v_exp_f32 v52, v68
    v_exp_f32 v53, v69
    v_exp_f32 v54, v70
    v_exp_f32 v55, v71
    v_pk_add_f32 v[40:41], v[40:41], 1.0 op_sel_hi:[1,0]
    v_pk_add_f32 v[42:43], v[42:43], 1.0 op_sel_hi:[1,0]
    v_pk_add_f32 v[44:45], v[44:45], 1.0 op_sel_hi:[1,0]
    v_pk_add_f32 v[46:47], v[46:47], 1.0 op_sel_hi:[1,0]
    v_pk_add_f32 v[48:49], v[48:49], 1.0 op_sel_hi:[1,0]
    v_pk_add_f32 v[50:51], v[50:51], 1.0 op_sel_hi:[1,0]
    v_pk_add_f32 v[52:53], v[52:53], 1.0 op_sel_hi:[1,0]
    v_pk_add_f32 v[54:55], v[54:55], 1.0 op_sel_hi:[1,0]
    v_rcp_f32 v40, v40
    v_rcp_f32 v41, v41
    v_rcp_f32 v42, v42
    v_rcp_f32 v43, v43
    v_rcp_f32 v44, v44
    v_rcp_f32 v45, v45
    v_rcp_f32 v46, v46
    v_rcp_f32 v47, v47
    v_rcp_f32 v48, v48
    v_rcp_f32 v49, v49
    v_rcp_f32 v50, v50
    v_rcp_f32 v51, v51
    v_rcp_f32 v52, v52
    v_rcp_f32 v53, v53
    v_rcp_f32 v54, v54
    v_rcp_f32 v55, v55
    v_pk_mul_f32 v[56:57], v[56:57], v[40:41]
    v_pk_mul_f32 v[58:59], v[58:59], v[42:43]
    v_pk_mul_f32 v[60:61], v[60:61], v[44:45]
    v_pk_mul_f32 v[62:63], v[62:63], v[46:47]
    v_pk_mul_f32 v[64:65], v[64:65], v[48:49]
    v_pk_mul_f32 v[66:67], v[66:67], v[50:51]
    v_pk_mul_f32 v[68:69], v[68:69], v[52:53]
    v_pk_mul_f32 v[70:71], v[70:71], v[54:55]
    v_pk_add_f32 v[56:57], v[56:57], v[58:59]
    v_pk_add_f32 v[60:61], v[60:61], v[62:63]
    v_pk_add_f32 v[64:65], v[64:65], v[66:67]
    v_pk_add_f32 v[68:69], v[68:69], v[70:71]
    v_pk_add_f32 v[56:57], v[56:57], v[60:61]
    v_pk_add_f32 v[64:65], v[64:65], v[68:69]
    v_cvt_f64_f32 v[232:233], v56
    v_cvt_f64_f32 v[234:235], v57
    v_cvt_f64_f32 v[236:237], v64
    v_cvt_f64_f32 v[238:239], v65
    ds_add_f64 v32, v[232:233] offset:0
    ds_add_f64 v33, v[234:235] offset:0
    ds_add_f64 v34, v[236:237] offset:0
    ds_add_f64 v35, v[238:239] offset:0
    s_waitcnt lgkmcnt(4)
    v_add_u32 v27, v26, v13
    v_lshrrev_b32 v27, 14, v27
    v_lshl_add_u32 v11, v27, 5, v12
    v_add_u32 v15, v15, v241
    v_add_u32 v36, v36, v14
    v_add_u32 v37, v37, v14
    v_add_u32 v38, v38, v14
    v_add_u32 v39, v39, v14
    ds_read_b128 v[112:115], v11 offset:0
    ds_read_b128 v[116:119], v11 offset:3584
    ds_read_u16 v16, v1 offset:512
    ds_read_u16 v18, v1 offset:528
    ds_read_u16 v20, v1 offset:576
    ds_read_u16 v22, v1 offset:592
    ds_read_b32 v24, v2 offset:512
    v_mfma_f32_32x32x16_bf16 v[56:71], v[88:91], v[152:155], 0
    v_mfma_f32_32x32x16_bf16 v[56:71], v[92:95], v[168:171], v[56:71]
    v_mfma_f32_32x32x16_bf16 v[56:71], v[96:99], v[184:187], v[56:71]
    v_mfma_f32_32x32x16_bf16 v[56:71], v[100:103], v[200:203], v[56:71]
    v_mfma_f32_32x32x16_bf16 v[56:71], v[104:107], v[136:139], v[56:71]
    v_mfma_f32_32x32x16_bf16 v[56:71], v[108:111], v[120:123], v[56:71]
    v_exp_f32 v40, v72
    v_exp_f32 v41, v73
    v_exp_f32 v42, v74
    v_exp_f32 v43, v75
    v_exp_f32 v44, v76
    v_exp_f32 v45, v77
    v_exp_f32 v46, v78
    v_exp_f32 v47, v79
    v_exp_f32 v48, v80
    v_exp_f32 v49, v81
    v_exp_f32 v50, v82
    v_exp_f32 v51, v83
    v_exp_f32 v52, v84
    v_exp_f32 v53, v85
    v_exp_f32 v54, v86
    v_exp_f32 v55, v87
    v_pk_add_f32 v[40:41], v[40:41], 1.0 op_sel_hi:[1,0]
    v_pk_add_f32 v[42:43], v[42:43], 1.0 op_sel_hi:[1,0]
    v_pk_add_f32 v[44:45], v[44:45], 1.0 op_sel_hi:[1,0]
    v_pk_add_f32 v[46:47], v[46:47], 1.0 op_sel_hi:[1,0]
    v_pk_add_f32 v[48:49], v[48:49], 1.0 op_sel_hi:[1,0]
    v_pk_add_f32 v[50:51], v[50:51], 1.0 op_sel_hi:[1,0]
    v_pk_add_f32 v[52:53], v[52:53], 1.0 op_sel_hi:[1,0]
    v_pk_add_f32 v[54:55], v[54:55], 1.0 op_sel_hi:[1,0]
    v_rcp_f32 v40, v40
    v_rcp_f32 v41, v41
    v_rcp_f32 v42, v42
    v_rcp_f32 v43, v43
    v_rcp_f32 v44, v44
    v_rcp_f32 v45, v45
    v_rcp_f32 v46, v46
    v_rcp_f32 v47, v47
    v_rcp_f32 v48, v48
    v_rcp_f32 v49, v49
    v_rcp_f32 v50, v50
    v_rcp_f32 v51, v51
    v_rcp_f32 v52, v52
    v_rcp_f32 v53, v53
    v_rcp_f32 v54, v54
    v_rcp_f32 v55, v55
    v_pk_mul_f32 v[72:73], v[72:73], v[40:41]
    v_pk_mul_f32 v[74:75], v[74:75], v[42:43]
    v_pk_mul_f32 v[76:77], v[76:77], v[44:45]
    v_pk_mul_f32 v[78:79], v[78:79], v[46:47]
    v_pk_mul_f32 v[80:81], v[80:81], v[48:49]
    v_pk_mul_f32 v[82:83], v[82:83], v[50:51]
    v_pk_mul_f32 v[84:85], v[84:85], v[52:53]
    v_pk_mul_f32 v[86:87], v[86:87], v[54:55]
    v_pk_add_f32 v[72:73], v[72:73], v[74:75]
    v_pk_add_f32 v[76:77], v[76:77], v[78:79]
    v_pk_add_f32 v[80:81], v[80:81], v[82:83]
    v_pk_add_f32 v[84:85], v[84:85], v[86:87]
    v_pk_add_f32 v[72:73], v[72:73], v[76:77]
    v_pk_add_f32 v[80:81], v[80:81], v[84:85]
    v_cvt_f64_f32 v[232:233], v72
    v_cvt_f64_f32 v[234:235], v73
    v_cvt_f64_f32 v[236:237], v80
    v_cvt_f64_f32 v[238:239], v81
    ds_add_f64 v32, v[232:233] offset:256
    ds_add_f64 v33, v[234:235] offset:256
    ds_add_f64 v34, v[236:237] offset:256
    ds_add_f64 v35, v[238:239] offset:256
    ds_read_b128 v[120:123], v11 offset:7168
    v_mfma_f32_32x32x16_bf16 v[72:87], v[88:91], v[156:159], 0
    v_mfma_f32_32x32x16_bf16 v[72:87], v[92:95], v[172:175], v[72:87]
    v_mfma_f32_32x32x16_bf16 v[72:87], v[96:99], v[188:191], v[72:87]
    v_mfma_f32_32x32x16_bf16 v[72:87], v[100:103], v[204:207], v[72:87]
    v_mfma_f32_32x32x16_bf16 v[72:87], v[104:107], v[140:143], v[72:87]
    v_mfma_f32_32x32x16_bf16 v[72:87], v[108:111], v[124:127], v[72:87]
    s_waitcnt vmcnt(1)
    ds_read_b128 v[88:91], v6
    ds_read_b128 v[92:95], v7
    ds_read_b128 v[96:99], v8
    ds_read_b128 v[100:103], v9
    ds_read_b128 v[108:111], v15 offset:1
    v_exp_f32 v40, v56
    v_exp_f32 v41, v57
    v_exp_f32 v42, v58
    v_exp_f32 v43, v59
    v_exp_f32 v44, v60
    v_exp_f32 v45, v61
    v_exp_f32 v46, v62
    v_exp_f32 v47, v63
    v_exp_f32 v48, v64
    v_exp_f32 v49, v65
    v_exp_f32 v50, v66
    v_exp_f32 v51, v67
    v_exp_f32 v52, v68
    v_exp_f32 v53, v69
    v_exp_f32 v54, v70
    v_exp_f32 v55, v71
    v_pk_add_f32 v[40:41], v[40:41], 1.0 op_sel_hi:[1,0]
    v_pk_add_f32 v[42:43], v[42:43], 1.0 op_sel_hi:[1,0]
    v_pk_add_f32 v[44:45], v[44:45], 1.0 op_sel_hi:[1,0]
    v_pk_add_f32 v[46:47], v[46:47], 1.0 op_sel_hi:[1,0]
    v_pk_add_f32 v[48:49], v[48:49], 1.0 op_sel_hi:[1,0]
    v_pk_add_f32 v[50:51], v[50:51], 1.0 op_sel_hi:[1,0]
    v_pk_add_f32 v[52:53], v[52:53], 1.0 op_sel_hi:[1,0]
    v_pk_add_f32 v[54:55], v[54:55], 1.0 op_sel_hi:[1,0]
    v_rcp_f32 v40, v40
    v_rcp_f32 v41, v41
    v_rcp_f32 v42, v42
    v_rcp_f32 v43, v43
    v_rcp_f32 v44, v44
    v_rcp_f32 v45, v45
    v_rcp_f32 v46, v46
    v_rcp_f32 v47, v47
    v_rcp_f32 v48, v48
    v_rcp_f32 v49, v49
    v_rcp_f32 v50, v50
    v_rcp_f32 v51, v51
    v_rcp_f32 v52, v52
    v_rcp_f32 v53, v53
    v_rcp_f32 v54, v54
    v_rcp_f32 v55, v55
    v_pk_mul_f32 v[56:57], v[56:57], v[40:41]
    v_pk_mul_f32 v[58:59], v[58:59], v[42:43]
    v_pk_mul_f32 v[60:61], v[60:61], v[44:45]
    v_pk_mul_f32 v[62:63], v[62:63], v[46:47]
    v_pk_mul_f32 v[64:65], v[64:65], v[48:49]
    v_pk_mul_f32 v[66:67], v[66:67], v[50:51]
    v_pk_mul_f32 v[68:69], v[68:69], v[52:53]
    v_pk_mul_f32 v[70:71], v[70:71], v[54:55]
    v_pk_add_f32 v[56:57], v[56:57], v[58:59]
    v_pk_add_f32 v[60:61], v[60:61], v[62:63]
    v_pk_add_f32 v[64:65], v[64:65], v[66:67]
    v_pk_add_f32 v[68:69], v[68:69], v[70:71]
    v_pk_add_f32 v[56:57], v[56:57], v[60:61]
    v_pk_add_f32 v[64:65], v[64:65], v[68:69]
    v_cvt_f64_f32 v[232:233], v56
    v_cvt_f64_f32 v[234:235], v57
    v_cvt_f64_f32 v[236:237], v64
    v_cvt_f64_f32 v[238:239], v65
    ds_add_f64 v32, v[232:233] offset:512
    ds_add_f64 v33, v[234:235] offset:512
    ds_add_f64 v34, v[236:237] offset:512
    ds_add_f64 v35, v[238:239] offset:512
    s_waitcnt lgkmcnt(4)
    s_add_u32 m0, s36, 0
    s_nop 0
    buffer_load_dwordx4 v[16:17], s[4:7], 0 idxen offen lds
    s_add_u32 m0, s36, 1024
    s_nop 0
    buffer_load_dwordx4 v[18:19], s[4:7], 0 idxen offen lds
    s_add_u32 m0, s36, 2048
    s_nop 0
    buffer_load_dwordx4 v[20:21], s[4:7], 0 idxen offen lds
    s_add_u32 m0, s36, 3072
    s_nop 0
    buffer_load_dwordx4 v[22:23], s[4:7], 0 idxen offen lds
    s_waitcnt vmcnt(4)
    buffer_load_dwordx4 v[104:107], v[24:25], s[8:11], 0 idxen offen
    ds_read_b128 v[124:127], v11 offset:10752
    v_mfma_f32_32x32x16_bf16 v[56:71], v[88:91], v[144:147], 0
    v_mfma_f32_32x32x16_bf16 v[56:71], v[92:95], v[160:163], v[56:71]
    v_mfma_f32_32x32x16_bf16 v[56:71], v[96:99], v[176:179], v[56:71]
    v_mfma_f32_32x32x16_bf16 v[56:71], v[100:103], v[192:195], v[56:71]
    v_mfma_f32_32x32x16_bf16 v[56:71], v[248:251], v[128:131], v[56:71]
    v_mfma_f32_32x32x16_bf16 v[56:71], v[108:111], v[112:115], v[56:71]
    v_exp_f32 v40, v72
    v_exp_f32 v41, v73
    v_exp_f32 v42, v74
    v_exp_f32 v43, v75
    v_exp_f32 v44, v76
    v_exp_f32 v45, v77
    v_exp_f32 v46, v78
    v_exp_f32 v47, v79
    v_exp_f32 v48, v80
    v_exp_f32 v49, v81
    v_exp_f32 v50, v82
    v_exp_f32 v51, v83
    v_exp_f32 v52, v84
    v_exp_f32 v53, v85
    v_exp_f32 v54, v86
    v_exp_f32 v55, v87
    v_pk_add_f32 v[40:41], v[40:41], 1.0 op_sel_hi:[1,0]
    v_pk_add_f32 v[42:43], v[42:43], 1.0 op_sel_hi:[1,0]
    v_pk_add_f32 v[44:45], v[44:45], 1.0 op_sel_hi:[1,0]
    v_pk_add_f32 v[46:47], v[46:47], 1.0 op_sel_hi:[1,0]
    v_pk_add_f32 v[48:49], v[48:49], 1.0 op_sel_hi:[1,0]
    v_pk_add_f32 v[50:51], v[50:51], 1.0 op_sel_hi:[1,0]
    v_pk_add_f32 v[52:53], v[52:53], 1.0 op_sel_hi:[1,0]
    v_pk_add_f32 v[54:55], v[54:55], 1.0 op_sel_hi:[1,0]
    v_rcp_f32 v40, v40
    v_rcp_f32 v41, v41
    v_rcp_f32 v42, v42
    v_rcp_f32 v43, v43
    v_rcp_f32 v44, v44
    v_rcp_f32 v45, v45
    v_rcp_f32 v46, v46
    v_rcp_f32 v47, v47
    v_rcp_f32 v48, v48
    v_rcp_f32 v49, v49
    v_rcp_f32 v50, v50
    v_rcp_f32 v51, v51
    v_rcp_f32 v52, v52
    v_rcp_f32 v53, v53
    v_rcp_f32 v54, v54
    v_rcp_f32 v55, v55
    v_pk_mul_f32 v[72:73], v[72:73], v[40:41]
    v_pk_mul_f32 v[74:75], v[74:75], v[42:43]
    v_pk_mul_f32 v[76:77], v[76:77], v[44:45]
    v_pk_mul_f32 v[78:79], v[78:79], v[46:47]
    v_pk_mul_f32 v[80:81], v[80:81], v[48:49]
    v_pk_mul_f32 v[82:83], v[82:83], v[50:51]
    v_pk_mul_f32 v[84:85], v[84:85], v[52:53]
    v_pk_mul_f32 v[86:87], v[86:87], v[54:55]
    v_pk_add_f32 v[72:73], v[72:73], v[74:75]
    v_pk_add_f32 v[76:77], v[76:77], v[78:79]
    v_pk_add_f32 v[80:81], v[80:81], v[82:83]
    v_pk_add_f32 v[84:85], v[84:85], v[86:87]
    v_pk_add_f32 v[72:73], v[72:73], v[76:77]
    v_pk_add_f32 v[80:81], v[80:81], v[84:85]
    v_cvt_f64_f32 v[232:233], v72
    v_cvt_f64_f32 v[234:235], v73
    v_cvt_f64_f32 v[236:237], v80
    v_cvt_f64_f32 v[238:239], v81
    ds_add_f64 v32, v[232:233] offset:768
    ds_add_f64 v33, v[234:235] offset:768
    ds_add_f64 v34, v[236:237] offset:768
    ds_add_f64 v35, v[238:239] offset:768
    s_sub_u32 s37, s37, 1
    s_cmp_eq_u32 s37, 1
    s_cbranch_scc0 B_W2S0
    s_mov_b32 s16, s60
    s_and_b32 s17, s61, 0xffff
    s_mov_b32 s18, 16384
    s_mov_b32 s19, 0x20000
    v_lshlrev_b32 v247, 4, v211
    s_lshl_b32 s24, s32, 11
    s_add_u32 m0, s24, 140544
    s_add_u32 s25, s24, 0
    buffer_load_dwordx4 v247, s[16:19], s25 offen lds
    s_add_u32 m0, s24, 141568
    s_add_u32 s25, s24, 1024
    buffer_load_dwordx4 v247, s[16:19], s25 offen lds
    s_mov_b32 s16, s62
    s_and_b32 s17, s63, 0xffff
    s_mov_b32 s18, 128
    s_mov_b32 s19, 0x20000
    s_mov_b32 m0, 156928
    s_nop 0
    buffer_load_dwordx4 v247, s[16:19], 0 offen lds
B_W2S0:
    s_cmp_eq_u32 s37, 0
    s_cbranch_scc1 B_LOOPEND
    ds_read_b128 v[32:35], v4 offset:64
    ds_read_b32 v26, v5 offset:64
    ds_read_u16 v15, v3 offset:512
    v_mfma_f32_32x32x16_bf16 v[72:87], v[88:91], v[148:151], 0
    v_mfma_f32_32x32x16_bf16 v[72:87], v[92:95], v[164:167], v[72:87]
    v_mfma_f32_32x32x16_bf16 v[72:87], v[96:99], v[180:183], v[72:87]
    v_mfma_f32_32x32x16_bf16 v[72:87], v[100:103], v[196:199], v[72:87]
    v_mfma_f32_32x32x16_bf16 v[72:87], v[248:251], v[132:135], v[72:87]
    v_mfma_f32_32x32x16_bf16 v[72:87], v[108:111], v[116:119], v[72:87]
    v_exp_f32 v40, v56
    v_exp_f32 v41, v57
    v_exp_f32 v42, v58
    v_exp_f32 v43, v59
    v_exp_f32 v44, v60
    v_exp_f32 v45, v61
    v_exp_f32 v46, v62
    v_exp_f32 v47, v63
    v_exp_f32 v48, v64
    v_exp_f32 v49, v65
    v_exp_f32 v50, v66
    v_exp_f32 v51, v67
    v_exp_f32 v52, v68
    v_exp_f32 v53, v69
    v_exp_f32 v54, v70
    v_exp_f32 v55, v71
    v_pk_add_f32 v[40:41], v[40:41], 1.0 op_sel_hi:[1,0]
    v_pk_add_f32 v[42:43], v[42:43], 1.0 op_sel_hi:[1,0]
    v_pk_add_f32 v[44:45], v[44:45], 1.0 op_sel_hi:[1,0]
    v_pk_add_f32 v[46:47], v[46:47], 1.0 op_sel_hi:[1,0]
    v_pk_add_f32 v[48:49], v[48:49], 1.0 op_sel_hi:[1,0]
    v_pk_add_f32 v[50:51], v[50:51], 1.0 op_sel_hi:[1,0]
    v_pk_add_f32 v[52:53], v[52:53], 1.0 op_sel_hi:[1,0]
    v_pk_add_f32 v[54:55], v[54:55], 1.0 op_sel_hi:[1,0]
    v_rcp_f32 v40, v40
    v_rcp_f32 v41, v41
    v_rcp_f32 v42, v42
    v_rcp_f32 v43, v43
    v_rcp_f32 v44, v44
    v_rcp_f32 v45, v45
    v_rcp_f32 v46, v46
    v_rcp_f32 v47, v47
    v_rcp_f32 v48, v48
    v_rcp_f32 v49, v49
    v_rcp_f32 v50, v50
    v_rcp_f32 v51, v51
    v_rcp_f32 v52, v52
    v_rcp_f32 v53, v53
    v_rcp_f32 v54, v54
    v_rcp_f32 v55, v55
    v_pk_mul_f32 v[56:57], v[56:57], v[40:41]
    v_pk_mul_f32 v[58:59], v[58:59], v[42:43]
    v_pk_mul_f32 v[60:61], v[60:61], v[44:45]
    v_pk_mul_f32 v[62:63], v[62:63], v[46:47]
    v_pk_mul_f32 v[64:65], v[64:65], v[48:49]
    v_pk_mul_f32 v[66:67], v[66:67], v[50:51]
    v_pk_mul_f32 v[68:69], v[68:69], v[52:53]
    v_pk_mul_f32 v[70:71], v[70:71], v[54:55]
    v_pk_add_f32 v[56:57], v[56:57], v[58:59]
    v_pk_add_f32 v[60:61], v[60:61], v[62:63]
    v_pk_add_f32 v[64:65], v[64:65], v[66:67]
    v_pk_add_f32 v[68:69], v[68:69], v[70:71]
    v_pk_add_f32 v[56:57], v[56:57], v[60:61]
    v_pk_add_f32 v[64:65], v[64:65], v[68:69]
    v_cvt_f64_f32 v[232:233], v56
    v_cvt_f64_f32 v[234:235], v57
    v_cvt_f64_f32 v[236:237], v64
    v_cvt_f64_f32 v[238:239], v65
    ds_add_f64 v36, v[232:233] offset:0
    ds_add_f64 v37, v[234:235] offset:0
    ds_add_f64 v38, v[236:237] offset:0
    ds_add_f64 v39, v[238:239] offset:0
    s_waitcnt lgkmcnt(4)
    v_add_u32 v27, v26, v13
    v_lshrrev_b32 v27, 14, v27
    v_lshl_add_u32 v11, v27, 5, v12
    v_add_u32 v15, v15, v241
    v_add_u32 v32, v32, v14
    v_add_u32 v33, v33, v14
    v_add_u32 v34, v34, v14
    v_add_u32 v35, v35, v14
    ds_read_b128 v[112:115], v11 offset:0
    ds_read_b128 v[116:119], v11 offset:3584
    ds_read_u16 v16, v1 offset:768
    ds_read_u16 v18, v1 offset:784
    ds_read_u16 v20, v1 offset:832
    ds_read_u16 v22, v1 offset:848
    ds_read_b32 v24, v2 offset:768
    v_mfma_f32_32x32x16_bf16 v[56:71], v[88:91], v[152:155], 0
    v_mfma_f32_32x32x16_bf16 v[56:71], v[92:95], v[168:171], v[56:71]
    v_mfma_f32_32x32x16_bf16 v[56:71], v[96:99], v[184:187], v[56:71]
    v_mfma_f32_32x32x16_bf16 v[56:71], v[100:103], v[200:203], v[56:71]
    v_mfma_f32_32x32x16_bf16 v[56:71], v[248:251], v[136:139], v[56:71]
    v_mfma_f32_32x32x16_bf16 v[56:71], v[108:111], v[120:123], v[56:71]
    v_exp_f32 v40, v72
    v_exp_f32 v41, v73
    v_exp_f32 v42, v74
    v_exp_f32 v43, v75
    v_exp_f32 v44, v76
    v_exp_f32 v45, v77
    v_exp_f32 v46, v78
    v_exp_f32 v47, v79
    v_exp_f32 v48, v80
    v_exp_f32 v49, v81
    v_exp_f32 v50, v82
    v_exp_f32 v51, v83
    v_exp_f32 v52, v84
    v_exp_f32 v53, v85
    v_exp_f32 v54, v86
    v_exp_f32 v55, v87
    v_pk_add_f32 v[40:41], v[40:41], 1.0 op_sel_hi:[1,0]
    v_pk_add_f32 v[42:43], v[42:43], 1.0 op_sel_hi:[1,0]
    v_pk_add_f32 v[44:45], v[44:45], 1.0 op_sel_hi:[1,0]
    v_pk_add_f32 v[46:47], v[46:47], 1.0 op_sel_hi:[1,0]
    v_pk_add_f32 v[48:49], v[48:49], 1.0 op_sel_hi:[1,0]
    v_pk_add_f32 v[50:51], v[50:51], 1.0 op_sel_hi:[1,0]
    v_pk_add_f32 v[52:53], v[52:53], 1.0 op_sel_hi:[1,0]
    v_pk_add_f32 v[54:55], v[54:55], 1.0 op_sel_hi:[1,0]
    v_rcp_f32 v40, v40
    v_rcp_f32 v41, v41
    v_rcp_f32 v42, v42
    v_rcp_f32 v43, v43
    v_rcp_f32 v44, v44
    v_rcp_f32 v45, v45
    v_rcp_f32 v46, v46
    v_rcp_f32 v47, v47
    v_rcp_f32 v48, v48
    v_rcp_f32 v49, v49
    v_rcp_f32 v50, v50
    v_rcp_f32 v51, v51
    v_rcp_f32 v52, v52
    v_rcp_f32 v53, v53
    v_rcp_f32 v54, v54
    v_rcp_f32 v55, v55
    v_pk_mul_f32 v[72:73], v[72:73], v[40:41]
    v_pk_mul_f32 v[74:75], v[74:75], v[42:43]
    v_pk_mul_f32 v[76:77], v[76:77], v[44:45]
    v_pk_mul_f32 v[78:79], v[78:79], v[46:47]
    v_pk_mul_f32 v[80:81], v[80:81], v[48:49]
    v_pk_mul_f32 v[82:83], v[82:83], v[50:51]
    v_pk_mul_f32 v[84:85], v[84:85], v[52:53]
    v_pk_mul_f32 v[86:87], v[86:87], v[54:55]
    v_pk_add_f32 v[72:73], v[72:73], v[74:75]
    v_pk_add_f32 v[76:77], v[76:77], v[78:79]
    v_pk_add_f32 v[80:81], v[80:81], v[82:83]
    v_pk_add_f32 v[84:85], v[84:85], v[86:87]
    v_pk_add_f32 v[72:73], v[72:73], v[76:77]
    v_pk_add_f32 v[80:81], v[80:81], v[84:85]
    v_cvt_f64_f32 v[232:233], v72
    v_cvt_f64_f32 v[234:235], v73
    v_cvt_f64_f32 v[236:237], v80
    v_cvt_f64_f32 v[238:239], v81
    ds_add_f64 v36, v[232:233] offset:256
    ds_add_f64 v37, v[234:235] offset:256
    ds_add_f64 v38, v[236:237] offset:256
    ds_add_f64 v39, v[238:239] offset:256
    ds_read_b128 v[120:123], v11 offset:7168
    v_mfma_f32_32x32x16_bf16 v[72:87], v[88:91], v[156:159], 0
    v_mfma_f32_32x32x16_bf16 v[72:87], v[92:95], v[172:175], v[72:87]
    v_mfma_f32_32x32x16_bf16 v[72:87], v[96:99], v[188:191], v[72:87]
    v_mfma_f32_32x32x16_bf16 v[72:87], v[100:103], v[204:207], v[72:87]
    v_mfma_f32_32x32x16_bf16 v[72:87], v[248:251], v[140:143], v[72:87]
    v_mfma_f32_32x32x16_bf16 v[72:87], v[108:111], v[124:127], v[72:87]
    s_waitcnt vmcnt(1)
    ds_read_b128 v[88:91], v6
    ds_read_b128 v[92:95], v7
    ds_read_b128 v[96:99], v8
    ds_read_b128 v[100:103], v9
    ds_read_b128 v[108:111], v15 offset:1
    v_exp_f32 v40, v56
    v_exp_f32 v41, v57
    v_exp_f32 v42, v58
    v_exp_f32 v43, v59
    v_exp_f32 v44, v60
    v_exp_f32 v45, v61
    v_exp_f32 v46, v62
    v_exp_f32 v47, v63
    v_exp_f32 v48, v64
    v_exp_f32 v49, v65
    v_exp_f32 v50, v66
    v_exp_f32 v51, v67
    v_exp_f32 v52, v68
    v_exp_f32 v53, v69
    v_exp_f32 v54, v70
    v_exp_f32 v55, v71
    v_pk_add_f32 v[40:41], v[40:41], 1.0 op_sel_hi:[1,0]
    v_pk_add_f32 v[42:43], v[42:43], 1.0 op_sel_hi:[1,0]
    v_pk_add_f32 v[44:45], v[44:45], 1.0 op_sel_hi:[1,0]
    v_pk_add_f32 v[46:47], v[46:47], 1.0 op_sel_hi:[1,0]
    v_pk_add_f32 v[48:49], v[48:49], 1.0 op_sel_hi:[1,0]
    v_pk_add_f32 v[50:51], v[50:51], 1.0 op_sel_hi:[1,0]
    v_pk_add_f32 v[52:53], v[52:53], 1.0 op_sel_hi:[1,0]
    v_pk_add_f32 v[54:55], v[54:55], 1.0 op_sel_hi:[1,0]
    v_rcp_f32 v40, v40
    v_rcp_f32 v41, v41
    v_rcp_f32 v42, v42
    v_rcp_f32 v43, v43
    v_rcp_f32 v44, v44
    v_rcp_f32 v45, v45
    v_rcp_f32 v46, v46
    v_rcp_f32 v47, v47
    v_rcp_f32 v48, v48
    v_rcp_f32 v49, v49
    v_rcp_f32 v50, v50
    v_rcp_f32 v51, v51
    v_rcp_f32 v52, v52
    v_rcp_f32 v53, v53
    v_rcp_f32 v54, v54
    v_rcp_f32 v55, v55
    v_pk_mul_f32 v[56:57], v[56:57], v[40:41]
    v_pk_mul_f32 v[58:59], v[58:59], v[42:43]
    v_pk_mul_f32 v[60:61], v[60:61], v[44:45]
    v_pk_mul_f32 v[62:63], v[62:63], v[46:47]
    v_pk_mul_f32 v[64:65], v[64:65], v[48:49]
    v_pk_mul_f32 v[66:67], v[66:67], v[50:51]
    v_pk_mul_f32 v[68:69], v[68:69], v[52:53]
    v_pk_mul_f32 v[70:71], v[70:71], v[54:55]
    v_pk_add_f32 v[56:57], v[56:57], v[58:59]
    v_pk_add_f32 v[60:61], v[60:61], v[62:63]
    v_pk_add_f32 v[64:65], v[64:65], v[66:67]
    v_pk_add_f32 v[68:69], v[68:69], v[70:71]
    v_pk_add_f32 v[56:57], v[56:57], v[60:61]
    v_pk_add_f32 v[64:65], v[64:65], v[68:69]
    v_cvt_f64_f32 v[232:233], v56
    v_cvt_f64_f32 v[234:235], v57
    v_cvt_f64_f32 v[236:237], v64
    v_cvt_f64_f32 v[238:239], v65
    ds_add_f64 v36, v[232:233] offset:512
    ds_add_f64 v37, v[234:235] offset:512
    ds_add_f64 v38, v[236:237] offset:512
    ds_add_f64 v39, v[238:239] offset:512
    s_waitcnt lgkmcnt(4)
    s_add_u32 m0, s36, 0
    s_nop 0
    buffer_load_dwordx4 v[16:17], s[4:7], 0 idxen offen lds
    s_add_u32 m0, s36, 1024
    s_nop 0
    buffer_load_dwordx4 v[18:19], s[4:7], 0 idxen offen lds
    s_add_u32 m0, s36, 2048
    s_nop 0
    buffer_load_dwordx4 v[20:21], s[4:7], 0 idxen offen lds
    s_add_u32 m0, s36, 3072
    s_nop 0
    buffer_load_dwordx4 v[22:23], s[4:7], 0 idxen offen lds
    s_waitcnt vmcnt(4)
    buffer_load_dwordx4 v[248:251], v[24:25], s[8:11], 0 idxen offen
    ds_read_b128 v[124:127], v11 offset:10752
    v_mfma_f32_32x32x16_bf16 v[56:71], v[88:91], v[144:147], 0
    v_mfma_f32_32x32x16_bf16 v[56:71], v[92:95], v[160:163], v[56:71]
    v_mfma_f32_32x32x16_bf16 v[56:71], v[96:99], v[176:179], v[56:71]
    v_mfma_f32_32x32x16_bf16 v[56:71], v[100:103], v[192:195], v[56:71]
    v_mfma_f32_32x32x16_bf16 v[56:71], v[104:107], v[128:131], v[56:71]
    v_mfma_f32_32x32x16_bf16 v[56:71], v[108:111], v[112:115], v[56:71]
    v_exp_f32 v40, v72
    v_exp_f32 v41, v73
    v_exp_f32 v42, v74
    v_exp_f32 v43, v75
    v_exp_f32 v44, v76
    v_exp_f32 v45, v77
    v_exp_f32 v46, v78
    v_exp_f32 v47, v79
    v_exp_f32 v48, v80
    v_exp_f32 v49, v81
    v_exp_f32 v50, v82
    v_exp_f32 v51, v83
    v_exp_f32 v52, v84
    v_exp_f32 v53, v85
    v_exp_f32 v54, v86
    v_exp_f32 v55, v87
    v_pk_add_f32 v[40:41], v[40:41], 1.0 op_sel_hi:[1,0]
    v_pk_add_f32 v[42:43], v[42:43], 1.0 op_sel_hi:[1,0]
    v_pk_add_f32 v[44:45], v[44:45], 1.0 op_sel_hi:[1,0]
    v_pk_add_f32 v[46:47], v[46:47], 1.0 op_sel_hi:[1,0]
    v_pk_add_f32 v[48:49], v[48:49], 1.0 op_sel_hi:[1,0]
    v_pk_add_f32 v[50:51], v[50:51], 1.0 op_sel_hi:[1,0]
    v_pk_add_f32 v[52:53], v[52:53], 1.0 op_sel_hi:[1,0]
    v_pk_add_f32 v[54:55], v[54:55], 1.0 op_sel_hi:[1,0]
    v_rcp_f32 v40, v40
    v_rcp_f32 v41, v41
    v_rcp_f32 v42, v42
    v_rcp_f32 v43, v43
    v_rcp_f32 v44, v44
    v_rcp_f32 v45, v45
    v_rcp_f32 v46, v46
    v_rcp_f32 v47, v47
    v_rcp_f32 v48, v48
    v_rcp_f32 v49, v49
    v_rcp_f32 v50, v50
    v_rcp_f32 v51, v51
    v_rcp_f32 v52, v52
    v_rcp_f32 v53, v53
    v_rcp_f32 v54, v54
    v_rcp_f32 v55, v55
    v_pk_mul_f32 v[72:73], v[72:73], v[40:41]
    v_pk_mul_f32 v[74:75], v[74:75], v[42:43]
    v_pk_mul_f32 v[76:77], v[76:77], v[44:45]
    v_pk_mul_f32 v[78:79], v[78:79], v[46:47]
    v_pk_mul_f32 v[80:81], v[80:81], v[48:49]
    v_pk_mul_f32 v[82:83], v[82:83], v[50:51]
    v_pk_mul_f32 v[84:85], v[84:85], v[52:53]
    v_pk_mul_f32 v[86:87], v[86:87], v[54:55]
    v_pk_add_f32 v[72:73], v[72:73], v[74:75]
    v_pk_add_f32 v[76:77], v[76:77], v[78:79]
    v_pk_add_f32 v[80:81], v[80:81], v[82:83]
    v_pk_add_f32 v[84:85], v[84:85], v[86:87]
    v_pk_add_f32 v[72:73], v[72:73], v[76:77]
    v_pk_add_f32 v[80:81], v[80:81], v[84:85]
    v_cvt_f64_f32 v[232:233], v72
    v_cvt_f64_f32 v[234:235], v73
    v_cvt_f64_f32 v[236:237], v80
    v_cvt_f64_f32 v[238:239], v81
    ds_add_f64 v36, v[232:233] offset:768
    ds_add_f64 v37, v[234:235] offset:768
    ds_add_f64 v38, v[236:237] offset:768
    ds_add_f64 v39, v[238:239] offset:768
    v_add_u32 v1, 512, v1
    v_add_u32 v2, 512, v2
    v_add_u32 v3, 512, v3
    v_add_u32 v4, 64, v4
    v_add_u32 v5, 64, v5
    s_sub_u32 s37, s37, 1
    s_cmp_eq_u32 s37, 1
    s_cbranch_scc0 B_W2S1
    s_mov_b32 s16, s60
    s_and_b32 s17, s61, 0xffff
    s_mov_b32 s18, 16384
    s_mov_b32 s19, 0x20000
    v_lshlrev_b32 v247, 4, v211
    s_lshl_b32 s24, s32, 11
    s_add_u32 m0, s24, 140544
    s_add_u32 s25, s24, 0
    buffer_load_dwordx4 v247, s[16:19], s25 offen lds
    s_add_u32 m0, s24, 141568
    s_add_u32 s25, s24, 1024
    buffer_load_dwordx4 v247, s[16:19], s25 offen lds
    s_mov_b32 s16, s62
    s_and_b32 s17, s63, 0xffff
    s_mov_b32 s18, 128
    s_mov_b32 s19, 0x20000
    s_mov_b32 m0, 156928
    s_nop 0
    buffer_load_dwordx4 v247, s[16:19], 0 offen lds
B_W2S1:
    s_cmp_eq_u32 s37, 0
    s_cbranch_scc0 B_LOOPS
    s_branch B_LOOPEND
B_NOTILES:
    s_mov_b32 s16, s60
    s_and_b32 s17, s61, 0xffff
    s_mov_b32 s18, 16384
    s_mov_b32 s19, 0x20000
    v_lshlrev_b32 v247, 4, v211
    s_lshl_b32 s24, s32, 11
    s_add_u32 m0, s24, 140544
    s_add_u32 s25, s24, 0
    buffer_load_dwordx4 v247, s[16:19], s25 offen lds
    s_add_u32 m0, s24, 141568
    s_add_u32 s25, s24, 1024
    buffer_load_dwordx4 v247, s[16:19], s25 offen lds
    s_mov_b32 s16, s62
    s_and_b32 s17, s63, 0xffff
    s_mov_b32 s18, 128
    s_mov_b32 s19, 0x20000
    s_mov_b32 m0, 156928
    s_nop 0
    buffer_load_dwordx4 v247, s[16:19], 0 offen lds
B_LOOPEND:
    s_setprio 0
    s_waitcnt vmcnt(0)
    v_lshrrev_b32 v3, 5, v211
    s_and_b32 s28, s32, 1
    s_lshl_b32 s28, s28, 6
    v_lshlrev_b32 v4, 3, v3
    v_add_u32 v4, s28, v4
    s_waitcnt vmcnt(0) lgkmcnt(0)
    s_barrier
    s_add_u32 s41, s41, s40
    s_cmp_ge_u32 s41, s42
    s_cbranch_scc1 B_FINISH
    v_lshlrev_b32 v27, 4, v0
    v_add_u32 v30, 114944, v27
    v_mov_b32 v40, -1
    v_mov_b32 v41, -1
    v_mov_b32 v42, -1
    v_mov_b32 v43, -1
    v_mov_b32 v44, 0
    v_mov_b32 v45, 0
    v_mov_b32 v46, 0
    v_mov_b32 v47, 0
    ds_write_b128 v30, v[40:43] offset:0
    ds_write_b128 v30, v[40:43] offset:8192
    ds_write_b128 v30, v[40:43] offset:16384
    v_cmp_gt_u32 vcc, 208, v0
    s_nop 0
    s_and_saveexec_b64 s[24:25], vcc
    ds_write_b128 v27, v[44:47] offset:57088
    v_cmp_gt_u32 vcc, 64, v0
    s_nop 0
    s_and_b64 exec, exec, vcc
    ds_write_b128 v30, v[40:43] offset:24576
    v_cmp_gt_u32 vcc, 16, v0
    s_nop 0
    s_and_b64 exec, exec, vcc
    ds_write_b128 v27, v[44:47] offset:40960
    s_mov_b64 exec, s[24:25]
    s_branch B_ROUND
B_OVERFLOW:
    s_mov_b32 s40, 8
B_RESTART:
    s_barrier
    s_mov_b32 s41, 0
    v_mov_b32 v210, 0
    v_mov_b32 v28, 0
    v_mov_b32 v29, 0
    v_lshlrev_b32 v27, 4, v0
    v_add_u32 v30, 114944, v27
    v_mov_b32 v40, -1
    v_mov_b32 v41, -1
    v_mov_b32 v42, -1
    v_mov_b32 v43, -1
    v_mov_b32 v44, 0
    v_mov_b32 v45, 0
    v_mov_b32 v46, 0
    v_mov_b32 v47, 0
    ds_write_b128 v30, v[40:43] offset:0
    ds_write_b128 v30, v[40:43] offset:8192
    ds_write_b128 v30, v[40:43] offset:16384
    v_cmp_gt_u32 vcc, 208, v0
    s_nop 0
    s_and_saveexec_b64 s[24:25], vcc
    ds_write_b128 v27, v[44:47] offset:57088
    v_cmp_gt_u32 vcc, 64, v0
    s_nop 0
    s_and_b64 exec, exec, vcc
    ds_write_b128 v30, v[40:43] offset:24576
    v_cmp_gt_u32 vcc, 16, v0
    s_nop 0
    s_and_b64 exec, exec, vcc
    ds_write_b128 v27, v[44:47] offset:40960
    s_mov_b64 exec, s[24:25]
    ds_write_b128 v27, v[44:47] offset:0
    ds_write_b128 v27, v[44:47] offset:8192
    ds_write_b128 v27, v[44:47] offset:16384
    ds_write_b128 v27, v[44:47] offset:24576
    ds_write_b128 v27, v[44:47] offset:32768
    s_branch B_ROUND
B_FINISH:
    v_lshlrev_b32 v27, 4, v0
    ds_read_b128 v[40:43], v27 offset:0
    ds_read_b128 v[44:47], v27 offset:8192
    ds_read_b128 v[48:51], v27 offset:16384
    ds_read_b128 v[52:55], v27 offset:24576
    ds_read_b128 v[56:59], v27 offset:32768
    v_lshrrev_b32 v27, 5, v211
    v_bfe_u32 v30, v211, 2, 2
    v_lshl_add_u32 v27, v27, 3, v30
    v_mul_u32_u24 v11, 128, v27
    v_bfe_u32 v27, v211, 4, 1
    v_lshl_add_u32 v11, v27, 5, v11
    v_and_b32 v27, 3, v211
    v_lshl_add_u32 v11, v27, 3, v11
    v_add_u32 v11, 140544, v11
    s_and_b32 s28, s32, 1
    s_lshl_b32 s28, s28, 6
    v_add_u32 v11, s28, v11
    v_mov_b32 v5, 0x71800000
    v_cmp_nlt_f32 vcc, v28, v5
    v_cmp_nlt_f32 s[24:25], v29, v5
    s_nop 0
    s_or_b64 vcc, vcc, s[24:25]
    v_lshlrev_b32 v6, 2, v211
    ds_write_b32 v6, v210 offset:42240
    v_add_u32 v6, 156928, v4
    ds_read_b64 v[104:105], v6 offset:0
    ds_read_b64 v[106:107], v6 offset:16
    ds_read_b64 v[108:109], v6 offset:32
    ds_read_b64 v[110:111], v6 offset:48
    ds_read_b64_tr_b16 v[216:217], v11 offset:0
    ds_read_b64_tr_b16 v[218:219], v11 offset:512
    ds_read_b64_tr_b16 v[220:221], v11 offset:2048
    ds_read_b64_tr_b16 v[222:223], v11 offset:2560
    ds_read_b64_tr_b16 v[224:225], v11 offset:4096
    ds_read_b64_tr_b16 v[226:227], v11 offset:4608
    ds_read_b64_tr_b16 v[228:229], v11 offset:6144
    ds_read_b64_tr_b16 v[230:231], v11 offset:6656
    v_lshrrev_b32 v7, 6, v0
    v_mul_u32_u24 v7, 272, v7
    v_and_b32 v8, 63, v0
    v_lshl_add_u32 v7, v8, 2, v7
    v_add_u32 v7, 114944, v7
    v_mov_b32 v9, 0xbf317218
    v_mov_b32 v10, 0
    s_waitcnt lgkmcnt(13)
    v_cvt_f32_f64 v72, v[40:41]
    v_cvt_f32_f64 v73, v[42:43]
    v_cvt_f32_f64 v74, v[44:45]
    v_cvt_f32_f64 v75, v[46:47]
    v_cvt_f32_f64 v76, v[48:49]
    v_cvt_f32_f64 v77, v[50:51]
    v_cvt_f32_f64 v78, v[52:53]
    v_cvt_f32_f64 v79, v[54:55]
    v_cvt_f32_f64 v80, v[56:57]
    v_cvt_f32_f64 v81, v[58:59]
    ds_read_b64_tr_b16 v[232:233], v11 offset:8192
    ds_read_b64_tr_b16 v[234:235], v11 offset:8704
    ds_read_b64_tr_b16 v[236:237], v11 offset:10240
    ds_read_b64_tr_b16 v[238:239], v11 offset:10752
    ds_read_b64_tr_b16 v[120:121], v11 offset:12288
    ds_read_b64_tr_b16 v[122:123], v11 offset:12800
    ds_read_b64_tr_b16 v[124:125], v11 offset:14336
    ds_read_b64_tr_b16 v[126:127], v11 offset:14848
    v_mul_f32 v72, v9, v72
    v_mul_f32 v73, v9, v73
    v_mul_f32 v74, v9, v74
    v_mul_f32 v75, v9, v75
    v_mul_f32 v76, v9, v76
    v_mul_f32 v77, v9, v77
    v_mul_f32 v78, v9, v78
    v_mul_f32 v79, v9, v79
    v_mul_f32 v80, v9, v80
    v_mul_f32 v81, v9, v81
    v_cvt_pk_bf16_f32 v40, v72, v73
    ds_write_b32 v7, v40 offset:0
    v_cvt_pk_bf16_f32 v41, v74, v75
    ds_write_b32 v7, v41 offset:2176
    v_cvt_pk_bf16_f32 v42, v76, v77
    ds_write_b32 v7, v42 offset:4352
    v_cvt_pk_bf16_f32 v43, v78, v79
    ds_write_b32 v7, v43 offset:6528
    v_cvt_pk_bf16_f32 v44, v80, v81
    ds_write_b32 v7, v44 offset:8704
    v_fmac_f32 v10, 0, v72
    v_fmac_f32 v10, 0, v73
    v_fmac_f32 v10, 0, v74
    v_fmac_f32 v10, 0, v75
    v_fmac_f32 v10, 0, v76
    v_fmac_f32 v10, 0, v77
    v_fmac_f32 v10, 0, v78
    v_fmac_f32 v10, 0, v79
    v_fmac_f32 v10, 0, v80
    v_fmac_f32 v10, 0, v81
    v_cmp_u_f32 s[24:25], v10, v10
    s_nop 0
    s_or_b64 vcc, vcc, s[24:25]
    s_cmp_eq_u64 vcc, 0
    s_cbranch_scc1 B_NOFLAG
    v_mov_b32 v5, 42496
    v_mov_b32 v6, 1
    ds_write_b32 v5, v6 offset:4
B_NOFLAG:
    s_lshr_b32 s28, s32, 1
    s_lshl_b32 s28, s28, 5
    v_and_b32 v2, 31, v211
    v_add_u32 v2, s28, v2
    v_mul_u32_u24 v5, 272, v2
    v_lshl_add_u32 v5, v3, 4, v5
    v_add_u32 v5, 114944, v5
    v_lshlrev_b32 v6, 2, v2
    v_add_u32 v8, s33, v2
    v_lshlrev_b32 v8, 7, v8
    v_add_u32 v8, v8, v4
    v_mov_b32 v9, 42496
    s_waitcnt lgkmcnt(12)
    v_lshlrev_b32 v40, 16, v104
    v_and_b32 v41, 0xffff0000, v104
    v_lshlrev_b32 v42, 16, v105
    v_and_b32 v43, 0xffff0000, v105
    v_lshlrev_b32 v44, 16, v106
    v_and_b32 v45, 0xffff0000, v106
    v_lshlrev_b32 v46, 16, v107
    v_and_b32 v47, 0xffff0000, v107
    v_lshlrev_b32 v48, 16, v108
    v_and_b32 v49, 0xffff0000, v108
    v_lshlrev_b32 v50, 16, v109
    v_and_b32 v51, 0xffff0000, v109
    v_lshlrev_b32 v52, 16, v110
    v_and_b32 v53, 0xffff0000, v110
    v_lshlrev_b32 v54, 16, v111
    v_and_b32 v55, 0xffff0000, v111
    s_mov_b32 s16, s96
    s_and_b32 s17, s97, 0xffff
    s_mov_b32 s18, 1280000
    s_mov_b32 s19, 0x20000
    s_waitcnt lgkmcnt(0)
    s_barrier
    ds_read_b32 v10, v9 offset:4
    ds_read_b32 v7, v6 offset:42240
    ds_read_b128 v[88:91], v5 offset:0
    ds_read_b128 v[92:95], v5 offset:32
    ds_read_b128 v[96:99], v5 offset:64
    ds_read_b128 v[100:103], v5 offset:96
    ds_read_b128 v[104:107], v5 offset:128
    ds_read_b128 v[108:111], v5 offset:160
    ds_read_b128 v[112:115], v5 offset:192
    ds_read_b128 v[116:119], v5 offset:224
    s_waitcnt lgkmcnt(9)
    v_readfirstlane_b32 s28, v10
    s_cmp_lg_u32 s39, 0
    s_cbranch_scc1 B_OUT
    s_cmp_eq_u32 s28, 0
    s_cbranch_scc1 B_OUT
    s_mov_b32 s39, 1
    s_waitcnt lgkmcnt(0)
    v_add_u32 v212, s35, v211
    v_and_b32 v212, 63, v212
    v_lshlrev_b32 v212, 2, v212
    v_and_b32 v119, 15, v211
    v_lshlrev_b32 v119, 5, v119
    v_add_u32 v119, 65023, v119
    v_lshlrev_b32 v213, 16, v119
    v_and_b32 v112, 31, v211
    v_lshrrev_b32 v113, 5, v211
    v_bfe_u32 v114, v211, 1, 3
    v_lshlrev_b32 v115, 7, v112
    v_add_u32 v115, s36, v115
    v_or_b32 v116, 0, v113
    v_xor_b32 v116, v116, v114
    v_lshl_add_u32 v6, v116, 4, v115
    v_or_b32 v116, 2, v113
    v_xor_b32 v116, v116, v114
    v_lshl_add_u32 v7, v116, 4, v115
    v_or_b32 v116, 4, v113
    v_xor_b32 v116, v116, v114
    v_lshl_add_u32 v8, v116, 4, v115
    v_or_b32 v116, 6, v113
    v_xor_b32 v116, v116, v114
    v_lshl_add_u32 v9, v116, 4, v115
    v_lshlrev_b32 v10, 4, v211
    v_add_u32 v10, s36, v10
    v_add_u32 v10, 0x1000, v10
    v_mul_u32_u24 v12, 112, v112
    v_lshl_add_u32 v12, v113, 4, v12
    v_add_u32 v12, 42752, v12
    v_xor_b32 v13, 1, v113
    v_lshlrev_b32 v13, 13, v13
    v_lshlrev_b32 v14, 3, v112
    v_lshlrev_b32 v241, 4, v113
    v_and_b32 v116, 7, v211
    v_lshrrev_b32 v117, 4, v211
    v_xor_b32 v118, v116, v117
    v_lshlrev_b32 v17, 4, v118
    v_mov_b32 v21, v17
    v_xor_b32 v118, 4, v118
    v_lshlrev_b32 v19, 4, v118
    v_mov_b32 v23, v19
    v_lshlrev_b32 v25, 4, v113
    v_bfe_u32 v116, v211, 3, 1
    v_bfe_u32 v117, v211, 4, 1
    v_lshlrev_b32 v118, 4, v113
    v_lshl_add_u32 v118, v116, 2, v118
    v_add_u32 v118, v118, v117
    v_lshlrev_b32 v242, 3, v118
    v_bfe_u32 v116, v211, 2, 1
    v_lshlrev_b32 v118, 4, v116
    v_bfe_u32 v116, v211, 4, 1
    v_lshl_add_u32 v118, v116, 3, v118
    v_and_b32 v116, 1, v211
    v_lshl_add_u32 v118, v116, 2, v118
    v_bfe_u32 v116, v211, 3, 1
    v_lshl_add_u32 v118, v116, 1, v118
    v_bfe_u32 v116, v211, 1, 1
    v_add_u32 v118, v118, v116
    v_lshlrev_b32 v244, 3, v118
    v_add_u32 v243, 4, v244
    v_add_u32 v244, 2, v244
    s_branch B_RESTART
B_OUT:
    s_cmp_ge_u32 s32, 4
    s_cbranch_scc1 B_END
    s_waitcnt lgkmcnt(7)
    v_mfma_f32_32x32x16_bf16 v[56:71], v[216:219], v[88:91], 0
    s_waitcnt lgkmcnt(6)
    v_mfma_f32_32x32x16_bf16 v[56:71], v[220:223], v[92:95], v[56:71]
    s_waitcnt lgkmcnt(5)
    v_mfma_f32_32x32x16_bf16 v[56:71], v[224:227], v[96:99], v[56:71]
    s_waitcnt lgkmcnt(4)
    v_mfma_f32_32x32x16_bf16 v[56:71], v[228:231], v[100:103], v[56:71]
    s_waitcnt lgkmcnt(3)
    v_mfma_f32_32x32x16_bf16 v[56:71], v[232:235], v[104:107], v[56:71]
    s_waitcnt lgkmcnt(2)
    v_mfma_f32_32x32x16_bf16 v[56:71], v[236:239], v[108:111], v[56:71]
    s_waitcnt lgkmcnt(1)
    v_mfma_f32_32x32x16_bf16 v[56:71], v[120:123], v[112:115], v[56:71]
    s_waitcnt lgkmcnt(0)
    v_mfma_f32_32x32x16_bf16 v[56:71], v[124:127], v[116:119], v[56:71]
    v_cvt_f32_u32 v7, v7
    v_cmp_gt_u32 vcc, s34, v2
    s_nop 9
    v_fma_f32 v56, v7, v40, v56
    v_fma_f32 v57, v7, v41, v57
    v_fma_f32 v58, v7, v42, v58
    v_fma_f32 v59, v7, v43, v59
    v_fma_f32 v60, v7, v44, v60
    v_fma_f32 v61, v7, v45, v61
    v_fma_f32 v62, v7, v46, v62
    v_fma_f32 v63, v7, v47, v63
    v_fma_f32 v64, v7, v48, v64
    v_fma_f32 v65, v7, v49, v65
    v_fma_f32 v66, v7, v50, v66
    v_fma_f32 v67, v7, v51, v67
    v_fma_f32 v68, v7, v52, v68
    v_fma_f32 v69, v7, v53, v69
    v_fma_f32 v70, v7, v54, v70
    v_fma_f32 v71, v7, v55, v71
    s_and_saveexec_b64 s[24:25], vcc
    v_cvt_pk_bf16_f32 v72, v56, v57
    v_cvt_pk_bf16_f32 v73, v58, v59
    buffer_store_dwordx2 v[72:73], v8, s[16:19], 0 offen offset:0
    v_cvt_pk_bf16_f32 v74, v60, v61
    v_cvt_pk_bf16_f32 v75, v62, v63
    buffer_store_dwordx2 v[74:75], v8, s[16:19], 0 offen offset:16
    v_cvt_pk_bf16_f32 v76, v64, v65
    v_cvt_pk_bf16_f32 v77, v66, v67
    buffer_store_dwordx2 v[76:77], v8, s[16:19], 0 offen offset:32
    v_cvt_pk_bf16_f32 v78, v68, v69
    v_cvt_pk_bf16_f32 v79, v70, v71
    buffer_store_dwordx2 v[78:79], v8, s[16:19], 0 offen offset:48
B_END:
    s_endpgm
.section .rodata,"a"
.p2align 6
.amdhsa_kernel gather_scatter__edge_featured_mpnn_mpnn__graph_kernel
  .amdhsa_next_free_vgpr 256
  .amdhsa_next_free_sgpr 102
  .amdhsa_accum_offset 256
  .amdhsa_group_segment_fixed_size 0
  .amdhsa_kernarg_size 88
  .amdhsa_user_sgpr_count 2
  .amdhsa_user_sgpr_kernarg_segment_ptr 1
  .amdhsa_system_sgpr_workgroup_id_x 1
.end_amdhsa_kernel
```
